```python
import torch

def _softmax(x, axis=-1):
    return torch.softmax(x, dim=axis)
def _gelu(x):
    return torch.nn.functional.gelu(x, approximate="tanh")
def _silu(x):
    return torch.nn.functional.silu(x)
def _sigmoid(x):
    return torch.sigmoid(x)
def _layernorm(x, axis=-1, eps=1e-5):
    m = x.mean(dim=axis, keepdim=True)
    v = x.var(dim=axis, keepdim=True, unbiased=False)
    return (x - m) / torch.sqrt(v + eps)
def _scatter_add(tgt, idx, src, axis=0):
    return tgt.clone().index_add_(axis, idx, src)
def _segment_sum(src, seg, n):
    out = torch.zeros((n,) + src.shape[1:], dtype=src.dtype)
    return out.index_add_(0, seg, src)
def _pad(x, pw):
    flat = tuple(v for pair in reversed(pw) for v in pair)
    return torch.nn.functional.pad(x, flat)

kernel_name = 'recurrent_scan__sliding_block_cached__mixer_token_mlp__decode'

def setup_inputs():

    _w = (lambda a: (lambda t: t.to(torch.bfloat16) if t.is_floating_point() else t)(torch.as_tensor(a)))
    def _A_setup():
        B, Sq, D = 1, 1, 640
        Hq, Hkv, Sk, Dh = 32, 32, 32768, 192
        assert Hq % Hkv == 0, (Hq, Hkv)
        return {
            "x": _w((lambda *s: torch.randn(*s, dtype=torch.bfloat16) * 0.1)(B, Sq, D)),
            "k_cache": _w((lambda *s: torch.randn(*s, dtype=torch.bfloat16) * 0.8)(B, Hkv, Sk, Dh)),
            "v_cache": _w((lambda *s: torch.randn(*s, dtype=torch.bfloat16) * 3.2)(B, Hkv, Sk, Dh)),
            "wq": _w((lambda *s: torch.randn(*s, dtype=torch.bfloat16) * 0.8)(D, Hq * Dh) * (D ** -0.5)),
            "wo": _w((lambda *s: torch.randn(*s, dtype=torch.bfloat16) * 3.2)(Hq * Dh, D) * ((Hq * Dh) ** -0.5)),
        }
    _A_in = _A_setup()

    def _B_setup():
        B, S, D, F = 1, 1, 640, 1536
        return {
            "x": _w((lambda *s: torch.randn(*s, dtype=torch.bfloat16) * 0.1)(B, S, D)),
            "w1": _w((lambda *s: torch.randn(*s, dtype=torch.bfloat16) * 3.2)(S, F) * (S ** -0.5)),
            "b1": _w((lambda *s: torch.randn(*s, dtype=torch.bfloat16) * 3.2)(F) * 0.02),
            "w2": _w((lambda *s: torch.randn(*s, dtype=torch.bfloat16) * 3.2)(F, S) * (F ** -0.5)),
            "b2": _w((lambda *s: torch.randn(*s, dtype=torch.bfloat16) * 3.2)(S) * 0.02),
        }
    _B_in = _B_setup()

    return {
        "A_x": _A_in["x"],
        "A_k_cache": _A_in["k_cache"],
        "A_v_cache": _A_in["v_cache"],
        "A_wq": _A_in["wq"],
        "A_wo": _A_in["wo"],
        "B_x": _B_in["x"],
        "B_w1": _B_in["w1"],
        "B_b1": _B_in["b1"],
        "B_w2": _B_in["w2"],
        "B_b2": _B_in["b2"],
    }

def reference(A_x, A_k_cache, A_v_cache, A_wq, A_wo, B_x, B_w1, B_b1, B_w2, B_b2):
    def _A_ref(x, k_cache, v_cache, wq, wo):
        B, Sq, D = x.shape
        Hq, Dh = 32, 192
        Hkv, Sk = k_cache.shape[1], k_cache.shape[2]
        W = min(4096, max(256, Sk // 4))
        rep = Hq // Hkv
        q = (lambda x, *d: x.permute(*d))((x @ wq).reshape(B, Sq, Hq, Dh), 0, 2, 1, 3)
        k = (lambda x, n, axis: torch.repeat_interleave(x, n, dim=axis))(k_cache[:, :, Sk - W:, :], rep, axis=1)
        v = (lambda x, n, axis: torch.repeat_interleave(x, n, dim=axis))(v_cache[:, :, Sk - W:, :], rep, axis=1)
        scores = torch.einsum("bhqd,bhkd->bhqk", q, k) * (Dh ** -0.5)
        p = _softmax(scores, axis=-1)
        o = torch.einsum("bhqk,bhkd->bhqd", p, v)
        return (lambda x, *d: x.permute(*d))(o, 0, 2, 1, 3).reshape(B, Sq, Hq * Dh) @ wo

    def _B_ref(x, w1, b1, w2, b2):
        B, S, D = x.shape
        h = _layernorm(x, axis=-1)
        u = torch.einsum("bsd,sf->bdf", h, w1) + b1
        u = _gelu(u)
        y = torch.einsum("bdf,fs->bds", u, w2) + b2
        return (lambda x, *d: x.permute(*d))(y, 0, 2, 1)

    x = A_x
    xn = _layernorm(x, axis=-1)
    s = _A_ref(xn, A_k_cache, A_v_cache, A_wq, A_wo)
    g = _silu(_B_ref(xn, B_w1, B_b1, B_w2, B_b2))
    return x + s * g
```

```asm
; @launch grid=(256,1,1) block=(512,1,1) lds=91520
.amdgcn_target "amdgcn-amd-amdhsa--gfx950"
.text
.globl recurrent_scan__sliding_block_cached__mixer_token_mlp__decode_kernel
.p2align 8
.type recurrent_scan__sliding_block_cached__mixer_token_mlp__decode_kernel,@function
recurrent_scan__sliding_block_cached__mixer_token_mlp__decode_kernel:
    s_cmp_ge_u32 s2, 256
    s_cbranch_scc1 K1_END
    s_load_dwordx16 s[16:31], s[0:1], 0
    s_load_dwordx8 s[32:39], s[0:1], 64
    s_load_dwordx2 s[40:41], s[0:1], 96
    v_and_b32 v1, 63, v0
    v_lshrrev_b32 v2, 3, v1
    v_and_b32 v3, 7, v1
    v_lshrrev_b32 v4, 6, v0
    s_nop 0
    v_readfirstlane_b32 s3, v4
    s_and_b32 s4, s2, 7
    s_lshr_b32 s5, s2, 3
    s_and_b32 s6, s5, 3
    s_lshl_b32 s4, s4, 2
    s_add_u32 s4, s4, s6
    s_lshr_b32 s5, s5, 2
    s_waitcnt lgkmcnt(0)
    s_mov_b32 s44, s16
    s_and_b32 s45, s17, 0xffff
    s_mov_b32 s46, 0x500
    s_mov_b32 s47, 0x00020000
    s_mov_b32 s48, s18
    s_and_b32 s49, s19, 0xffff
    s_mov_b32 s50, 0x18000000
    s_mov_b32 s51, 0x00020000
    s_mov_b32 s52, s20
    s_and_b32 s53, s21, 0xffff
    s_mov_b32 s54, 0x18000000
    s_mov_b32 s55, 0x00020000
    s_mov_b32 s56, s22
    s_and_b32 s57, s23, 0xffff
    s_mov_b32 s58, 0x780000
    s_mov_b32 s59, 0x00020000
    s_mov_b32 s60, s28
    s_and_b32 s61, s29, 0xffff
    s_mov_b32 s62, 0xc00
    s_mov_b32 s63, 0x00020000
    s_mov_b32 s64, s30
    s_and_b32 s65, s31, 0xffff
    s_mov_b32 s66, 0xc00
    s_mov_b32 s67, 0x00020000
    s_mov_b32 s68, s32
    s_and_b32 s69, s33, 0xffff
    s_mov_b32 s70, 0xc00
    s_mov_b32 s71, 0x00020000
    s_mov_b32 s72, s34
    s_and_b32 s73, s35, 0xffff
    s_mov_b32 s74, 0x2
    s_mov_b32 s75, 0x00020000
    s_mov_b32 s76, s40
    s_and_b32 s77, s41, 0xffff
    s_mov_b32 s78, 0x60000000
    s_mov_b32 s79, 0x00020000
    s_mov_b32 s13, s5
    s_mul_i32 s7, s4, 12582912
    s_lshl_b32 s8, s5, 9
    s_mul_i32 s9, s3, 64
    s_add_u32 s8, s8, s9
    s_add_u32 s8, s8, 28672
    s_mul_i32 s8, s8, 384
    s_add_u32 s7, s7, s8
    v_mul_u32_u24 v5, 384, v2
    v_lshl_add_u32 v5, v3, 4, v5
    v_add_u32 v5, s7, v5
    s_lshl_b32 s8, s3, 3
    v_add_u32 v6, s8, v2
    v_mov_b32 v7, v6
    v_mul_u32_u24 v6, 12288, v6
    v_lshl_add_u32 v6, v3, 4, v6
    s_mul_i32 s8, s4, 384
    v_add_u32 v6, s8, v6
    v_lshlrev_b32 v8, 2, v1
    v_lshlrev_b32 v9, 2, v0
    buffer_load_dword v10, v8, s[44:47], 0 offen offset:0
    buffer_load_dword v11, v8, s[44:47], 0 offen offset:256
    buffer_load_dword v12, v8, s[44:47], 0 offen offset:512
    buffer_load_dword v13, v8, s[44:47], 0 offen offset:768
    buffer_load_dword v14, v8, s[44:47], 0 offen offset:1024
    v_and_b32 v64, 0x3ff, v9
    buffer_load_dword v15, v64, s[60:63], 0 offen offset:0
    buffer_load_dword v18, v64, s[64:67], 0 offen offset:0
    buffer_load_dword v21, v64, s[68:71], 0 offen offset:0
    buffer_load_dword v16, v64, s[60:63], 0 offen offset:1024
    buffer_load_dword v19, v64, s[64:67], 0 offen offset:1024
    buffer_load_dword v22, v64, s[68:71], 0 offen offset:1024
    buffer_load_dword v17, v64, s[60:63], 0 offen offset:2048
    buffer_load_dword v20, v64, s[64:67], 0 offen offset:2048
    buffer_load_dword v23, v64, s[68:71], 0 offen offset:2048
    v_mov_b32 v65, 0
    buffer_load_ushort v74, v65, s[72:75], 0 offen
    s_mov_b32 s84, s24
    s_and_b32 s85, s25, 0xffff
    s_mov_b32 s86, 0x780000
    s_mov_b32 s87, 0x00020000
    s_mov_b32 s88, s38
    s_and_b32 s89, s39, 0xffff
    s_mov_b32 s90, 0x100
    s_mov_b32 s91, 0x00020000
    s_mov_b32 s92, s36
    s_and_b32 s93, s37, 0xffff
    s_mov_b32 s94, 0x500
    s_mov_b32 s95, 0x00020000
    v_mul_u32_u24 v64, 205, v0
    v_lshrrev_b32 v64, 11, v64
    v_mul_u32_u24 v65, 10, v64
    v_sub_u32 v65, v0, v65
    s_mul_i32 s8, s4, 192
    v_add_u32 v75, s8, v64
    v_mul_u32_u24 v75, 1280, v75
    v_lshl_add_u32 v75, v65, 4, v75
    s_mul_i32 s8, s13, 160
    v_add_u32 v75, s8, v75
    s_mov_b32 s10, 0
    buffer_load_dwordx4 v[88:91], v6, s[56:59], s10 offen offset:0 nt
    buffer_load_dwordx4 v[92:95], v6, s[56:59], s10 offen offset:128 nt
    buffer_load_dwordx4 v[96:99], v6, s[56:59], s10 offen offset:256 nt
    s_mov_b32 s10, 0
    buffer_load_dwordx4 v[100:103], v5, s[48:51], s10 offen offset:0 nt
    buffer_load_dwordx4 v[104:107], v5, s[48:51], s10 offen offset:128 nt
    buffer_load_dwordx4 v[108:111], v5, s[48:51], s10 offen offset:256 nt
    s_mov_b32 s10, 786432
    buffer_load_dwordx4 v[112:115], v6, s[56:59], s10 offen offset:0 nt
    buffer_load_dwordx4 v[116:119], v6, s[56:59], s10 offen offset:128 nt
    buffer_load_dwordx4 v[120:123], v6, s[56:59], s10 offen offset:256 nt
    s_mov_b32 s10, 3072
    buffer_load_dwordx4 v[124:127], v5, s[48:51], s10 offen offset:0 nt
    buffer_load_dwordx4 v[128:131], v5, s[48:51], s10 offen offset:128 nt
    buffer_load_dwordx4 v[132:135], v5, s[48:51], s10 offen offset:256 nt
    s_mov_b32 s10, 1572864
    buffer_load_dwordx4 v[136:139], v6, s[56:59], s10 offen offset:0 nt
    buffer_load_dwordx4 v[140:143], v6, s[56:59], s10 offen offset:128 nt
    buffer_load_dwordx4 v[144:147], v6, s[56:59], s10 offen offset:256 nt
    s_mov_b32 s10, 6144
    buffer_load_dwordx4 v[148:151], v5, s[48:51], s10 offen offset:0 nt
    buffer_load_dwordx4 v[152:155], v5, s[48:51], s10 offen offset:128 nt
    buffer_load_dwordx4 v[156:159], v5, s[48:51], s10 offen offset:256 nt
    s_mov_b32 s10, 2359296
    buffer_load_dwordx4 v[160:163], v6, s[56:59], s10 offen offset:0 nt
    buffer_load_dwordx4 v[164:167], v6, s[56:59], s10 offen offset:128 nt
    buffer_load_dwordx4 v[168:171], v6, s[56:59], s10 offen offset:256 nt
    s_mov_b32 s10, 9216
    buffer_load_dwordx4 v[172:175], v5, s[48:51], s10 offen offset:0 nt
    buffer_load_dwordx4 v[176:179], v5, s[48:51], s10 offen offset:128 nt
    buffer_load_dwordx4 v[180:183], v5, s[48:51], s10 offen offset:256 nt
    s_mov_b32 s10, 3145728
    buffer_load_dwordx4 v[184:187], v6, s[56:59], s10 offen offset:0 nt
    buffer_load_dwordx4 v[188:191], v6, s[56:59], s10 offen offset:128 nt
    buffer_load_dwordx4 v[192:195], v6, s[56:59], s10 offen offset:256 nt
    s_mov_b32 s10, 12288
    buffer_load_dwordx4 v[196:199], v5, s[48:51], s10 offen offset:0 nt
    buffer_load_dwordx4 v[200:203], v5, s[48:51], s10 offen offset:128 nt
    buffer_load_dwordx4 v[204:207], v5, s[48:51], s10 offen offset:256 nt
    s_mov_b32 s10, 3932160
    buffer_load_dwordx4 v[208:211], v6, s[56:59], s10 offen offset:0 nt
    buffer_load_dwordx4 v[212:215], v6, s[56:59], s10 offen offset:128 nt
    buffer_load_dwordx4 v[216:219], v6, s[56:59], s10 offen offset:256 nt
    s_mov_b32 s10, 15360
    buffer_load_dwordx4 v[220:223], v5, s[48:51], s10 offen offset:0 nt
    buffer_load_dwordx4 v[224:227], v5, s[48:51], s10 offen offset:128 nt
    buffer_load_dwordx4 v[228:231], v5, s[48:51], s10 offen offset:256 nt
    s_mov_b32 s10, 4718592
    buffer_load_dwordx4 v[232:235], v6, s[56:59], s10 offen offset:0 nt
    buffer_load_dwordx4 v[236:239], v6, s[56:59], s10 offen offset:128 nt
    buffer_load_dwordx4 v[240:243], v6, s[56:59], s10 offen offset:256 nt
    s_mov_b32 s10, 18432
    buffer_load_dwordx4 v[244:247], v5, s[48:51], s10 offen offset:0 nt
    buffer_load_dwordx4 v[248:251], v5, s[48:51], s10 offen offset:128 nt
    buffer_load_dwordx4 v[252:255], v5, s[48:51], s10 offen offset:256 nt
    s_memrealtime s[98:99]
    s_waitcnt lgkmcnt(0)
    s_or_b32 s98, s98, 1
    v_mov_b32 v76, s98
    v_mov_b32 v77, 0
    v_mov_b32 v66, 0
    s_cmp_lg_u32 s3, 0
    s_cbranch_scc1 K1_NONONCE
    s_mov_b64 exec, 1
    buffer_atomic_cmpswap v[76:77], v66, s[88:91], 0 offen sc0
    s_mov_b64 exec, -1
K1_NONONCE:
    s_waitcnt vmcnt(52)
    v_lshlrev_b32 v24, 16, v10
    v_and_b32 v25, 0xffff0000, v10
    v_lshlrev_b32 v26, 16, v11
    v_and_b32 v27, 0xffff0000, v11
    v_lshlrev_b32 v28, 16, v12
    v_and_b32 v29, 0xffff0000, v12
    v_lshlrev_b32 v30, 16, v13
    v_and_b32 v31, 0xffff0000, v13
    v_lshlrev_b32 v32, 16, v14
    v_and_b32 v33, 0xffff0000, v14
    v_add_f32 v64, v24, v25
    v_add_f32 v64, v64, v26
    v_add_f32 v64, v64, v27
    v_add_f32 v64, v64, v28
    v_add_f32 v64, v64, v29
    v_add_f32 v64, v64, v30
    v_add_f32 v64, v64, v31
    v_add_f32 v64, v64, v32
    v_add_f32 v64, v64, v33
    s_nop 1
    v_add_f32_dpp v65, v64, v64 quad_perm:[1,0,3,2] row_mask:0xf bank_mask:0xf
    s_nop 1
    v_add_f32_dpp v65, v65, v65 quad_perm:[2,3,0,1] row_mask:0xf bank_mask:0xf
    s_nop 1
    v_add_f32_dpp v65, v65, v65 row_half_mirror row_mask:0xf bank_mask:0xf
    s_nop 1
    v_add_f32_dpp v65, v65, v65 row_mirror row_mask:0xf bank_mask:0xf
    s_nop 1
    v_readlane_b32 s80, v65, 0
    v_readlane_b32 s81, v65, 16
    v_readlane_b32 s82, v65, 32
    v_readlane_b32 s83, v65, 48
    s_nop 1
    v_mov_b32 v65, s80
    v_add_f32 v65, s81, v65
    v_add_f32 v65, s82, v65
    v_add_f32 v65, s83, v65
    v_mul_f32 v65, 0x3acccccd, v65
    v_sub_f32 v66, v24, v65
    v_mul_f32 v64, v66, v66
    v_sub_f32 v66, v25, v65
    v_fmac_f32 v64, v66, v66
    v_sub_f32 v66, v26, v65
    v_fmac_f32 v64, v66, v66
    v_sub_f32 v66, v27, v65
    v_fmac_f32 v64, v66, v66
    v_sub_f32 v66, v28, v65
    v_fmac_f32 v64, v66, v66
    v_sub_f32 v66, v29, v65
    v_fmac_f32 v64, v66, v66
    v_sub_f32 v66, v30, v65
    v_fmac_f32 v64, v66, v66
    v_sub_f32 v66, v31, v65
    v_fmac_f32 v64, v66, v66
    v_sub_f32 v66, v32, v65
    v_fmac_f32 v64, v66, v66
    v_sub_f32 v66, v33, v65
    v_fmac_f32 v64, v66, v66
    s_nop 1
    v_add_f32_dpp v66, v64, v64 quad_perm:[1,0,3,2] row_mask:0xf bank_mask:0xf
    s_nop 1
    v_add_f32_dpp v66, v66, v66 quad_perm:[2,3,0,1] row_mask:0xf bank_mask:0xf
    s_nop 1
    v_add_f32_dpp v66, v66, v66 row_half_mirror row_mask:0xf bank_mask:0xf
    s_nop 1
    v_add_f32_dpp v66, v66, v66 row_mirror row_mask:0xf bank_mask:0xf
    s_nop 1
    v_readlane_b32 s80, v66, 0
    v_readlane_b32 s81, v66, 16
    v_readlane_b32 s82, v66, 32
    v_readlane_b32 s83, v66, 48
    s_nop 1
    v_mov_b32 v66, s80
    v_add_f32 v66, s81, v66
    v_add_f32 v66, s82, v66
    v_add_f32 v66, s83, v66
    v_mul_f32 v66, 0x3acccccd, v66
    v_cvt_pk_bf16_f32 v65, v65, v65
    v_lshlrev_b32 v65, 16, v65
    v_cvt_pk_bf16_f32 v66, v66, v66
    v_lshlrev_b32 v66, 16, v66
    v_add_f32 v66, 0x3727c5ac, v66
    v_cvt_pk_bf16_f32 v66, v66, v66
    v_lshlrev_b32 v66, 16, v66
    v_sqrt_f32 v66, v66
    s_nop 0
    v_cvt_pk_bf16_f32 v66, v66, v66
    v_lshlrev_b32 v66, 16, v66
    v_rcp_f32 v67, v66
    s_nop 0
    v_sub_f32 v68, v24, v65
    v_cvt_pk_bf16_f32 v68, v68, v68
    v_lshlrev_b32 v68, 16, v68
    v_mul_f32 v69, v68, v67
    v_fma_f32 v68, -v69, v66, v68
    v_fma_f32 v69, v68, v67, v69
    v_cvt_pk_bf16_f32 v24, v69, v69
    v_lshlrev_b32 v24, 16, v24
    v_sub_f32 v68, v25, v65
    v_cvt_pk_bf16_f32 v68, v68, v68
    v_lshlrev_b32 v68, 16, v68
    v_mul_f32 v69, v68, v67
    v_fma_f32 v68, -v69, v66, v68
    v_fma_f32 v69, v68, v67, v69
    v_cvt_pk_bf16_f32 v25, v69, v69
    v_lshlrev_b32 v25, 16, v25
    v_sub_f32 v68, v26, v65
    v_cvt_pk_bf16_f32 v68, v68, v68
    v_lshlrev_b32 v68, 16, v68
    v_mul_f32 v69, v68, v67
    v_fma_f32 v68, -v69, v66, v68
    v_fma_f32 v69, v68, v67, v69
    v_cvt_pk_bf16_f32 v26, v69, v69
    v_lshlrev_b32 v26, 16, v26
    v_sub_f32 v68, v27, v65
    v_cvt_pk_bf16_f32 v68, v68, v68
    v_lshlrev_b32 v68, 16, v68
    v_mul_f32 v69, v68, v67
    v_fma_f32 v68, -v69, v66, v68
    v_fma_f32 v69, v68, v67, v69
    v_cvt_pk_bf16_f32 v27, v69, v69
    v_lshlrev_b32 v27, 16, v27
    v_sub_f32 v68, v28, v65
    v_cvt_pk_bf16_f32 v68, v68, v68
    v_lshlrev_b32 v68, 16, v68
    v_mul_f32 v69, v68, v67
    v_fma_f32 v68, -v69, v66, v68
    v_fma_f32 v69, v68, v67, v69
    v_cvt_pk_bf16_f32 v28, v69, v69
    v_lshlrev_b32 v28, 16, v28
    v_sub_f32 v68, v29, v65
    v_cvt_pk_bf16_f32 v68, v68, v68
    v_lshlrev_b32 v68, 16, v68
    v_mul_f32 v69, v68, v67
    v_fma_f32 v68, -v69, v66, v68
    v_fma_f32 v69, v68, v67, v69
    v_cvt_pk_bf16_f32 v29, v69, v69
    v_lshlrev_b32 v29, 16, v29
    v_sub_f32 v68, v30, v65
    v_cvt_pk_bf16_f32 v68, v68, v68
    v_lshlrev_b32 v68, 16, v68
    v_mul_f32 v69, v68, v67
    v_fma_f32 v68, -v69, v66, v68
    v_fma_f32 v69, v68, v67, v69
    v_cvt_pk_bf16_f32 v30, v69, v69
    v_lshlrev_b32 v30, 16, v30
    v_sub_f32 v68, v31, v65
    v_cvt_pk_bf16_f32 v68, v68, v68
    v_lshlrev_b32 v68, 16, v68
    v_mul_f32 v69, v68, v67
    v_fma_f32 v68, -v69, v66, v68
    v_fma_f32 v69, v68, v67, v69
    v_cvt_pk_bf16_f32 v31, v69, v69
    v_lshlrev_b32 v31, 16, v31
    v_sub_f32 v68, v32, v65
    v_cvt_pk_bf16_f32 v68, v68, v68
    v_lshlrev_b32 v68, 16, v68
    v_mul_f32 v69, v68, v67
    v_fma_f32 v68, -v69, v66, v68
    v_fma_f32 v69, v68, v67, v69
    v_cvt_pk_bf16_f32 v32, v69, v69
    v_lshlrev_b32 v32, 16, v32
    v_sub_f32 v68, v33, v65
    v_cvt_pk_bf16_f32 v68, v68, v68
    v_lshlrev_b32 v68, 16, v68
    v_mul_f32 v69, v68, v67
    v_fma_f32 v68, -v69, v66, v68
    v_fma_f32 v69, v68, v67, v69
    v_cvt_pk_bf16_f32 v33, v69, v69
    v_lshlrev_b32 v33, 16, v33
    v_add_f32 v64, v24, v25
    v_add_f32 v64, v64, v26
    v_add_f32 v64, v64, v27
    v_add_f32 v64, v64, v28
    v_add_f32 v64, v64, v29
    v_add_f32 v64, v64, v30
    v_add_f32 v64, v64, v31
    v_add_f32 v64, v64, v32
    v_add_f32 v64, v64, v33
    s_nop 1
    v_add_f32_dpp v65, v64, v64 quad_perm:[1,0,3,2] row_mask:0xf bank_mask:0xf
    s_nop 1
    v_add_f32_dpp v65, v65, v65 quad_perm:[2,3,0,1] row_mask:0xf bank_mask:0xf
    s_nop 1
    v_add_f32_dpp v65, v65, v65 row_half_mirror row_mask:0xf bank_mask:0xf
    s_nop 1
    v_add_f32_dpp v65, v65, v65 row_mirror row_mask:0xf bank_mask:0xf
    s_nop 1
    v_readlane_b32 s80, v65, 0
    v_readlane_b32 s81, v65, 16
    v_readlane_b32 s82, v65, 32
    v_readlane_b32 s83, v65, 48
    s_nop 1
    v_mov_b32 v65, s80
    v_add_f32 v65, s81, v65
    v_add_f32 v65, s82, v65
    v_add_f32 v65, s83, v65
    v_mul_f32 v65, 0x3acccccd, v65
    v_sub_f32 v66, v24, v65
    v_mul_f32 v64, v66, v66
    v_sub_f32 v66, v25, v65
    v_fmac_f32 v64, v66, v66
    v_sub_f32 v66, v26, v65
    v_fmac_f32 v64, v66, v66
    v_sub_f32 v66, v27, v65
    v_fmac_f32 v64, v66, v66
    v_sub_f32 v66, v28, v65
    v_fmac_f32 v64, v66, v66
    v_sub_f32 v66, v29, v65
    v_fmac_f32 v64, v66, v66
    v_sub_f32 v66, v30, v65
    v_fmac_f32 v64, v66, v66
    v_sub_f32 v66, v31, v65
    v_fmac_f32 v64, v66, v66
    v_sub_f32 v66, v32, v65
    v_fmac_f32 v64, v66, v66
    v_sub_f32 v66, v33, v65
    v_fmac_f32 v64, v66, v66
    s_nop 1
    v_add_f32_dpp v66, v64, v64 quad_perm:[1,0,3,2] row_mask:0xf bank_mask:0xf
    s_nop 1
    v_add_f32_dpp v66, v66, v66 quad_perm:[2,3,0,1] row_mask:0xf bank_mask:0xf
    s_nop 1
    v_add_f32_dpp v66, v66, v66 row_half_mirror row_mask:0xf bank_mask:0xf
    s_nop 1
    v_add_f32_dpp v66, v66, v66 row_mirror row_mask:0xf bank_mask:0xf
    s_nop 1
    v_readlane_b32 s80, v66, 0
    v_readlane_b32 s81, v66, 16
    v_readlane_b32 s82, v66, 32
    v_readlane_b32 s83, v66, 48
    s_nop 1
    v_mov_b32 v66, s80
    v_add_f32 v66, s81, v66
    v_add_f32 v66, s82, v66
    v_add_f32 v66, s83, v66
    v_mul_f32 v66, 0x3acccccd, v66
    v_cvt_pk_bf16_f32 v65, v65, v65
    v_lshlrev_b32 v65, 16, v65
    v_cvt_pk_bf16_f32 v66, v66, v66
    v_lshlrev_b32 v66, 16, v66
    v_add_f32 v66, 0x3727c5ac, v66
    v_cvt_pk_bf16_f32 v66, v66, v66
    v_lshlrev_b32 v66, 16, v66
    v_sqrt_f32 v66, v66
    s_nop 0
    v_cvt_pk_bf16_f32 v66, v66, v66
    v_lshlrev_b32 v66, 16, v66
    v_rcp_f32 v67, v66
    s_nop 0
    v_sub_f32 v68, v24, v65
    v_cvt_pk_bf16_f32 v68, v68, v68
    v_lshlrev_b32 v68, 16, v68
    v_mul_f32 v69, v68, v67
    v_fma_f32 v68, -v69, v66, v68
    v_fma_f32 v69, v68, v67, v69
    v_cvt_pk_bf16_f32 v34, v69, v69
    v_lshlrev_b32 v34, 16, v34
    v_sub_f32 v68, v25, v65
    v_cvt_pk_bf16_f32 v68, v68, v68
    v_lshlrev_b32 v68, 16, v68
    v_mul_f32 v69, v68, v67
    v_fma_f32 v68, -v69, v66, v68
    v_fma_f32 v69, v68, v67, v69
    v_cvt_pk_bf16_f32 v35, v69, v69
    v_lshlrev_b32 v35, 16, v35
    v_sub_f32 v68, v26, v65
    v_cvt_pk_bf16_f32 v68, v68, v68
    v_lshlrev_b32 v68, 16, v68
    v_mul_f32 v69, v68, v67
    v_fma_f32 v68, -v69, v66, v68
    v_fma_f32 v69, v68, v67, v69
    v_cvt_pk_bf16_f32 v36, v69, v69
    v_lshlrev_b32 v36, 16, v36
    v_sub_f32 v68, v27, v65
    v_cvt_pk_bf16_f32 v68, v68, v68
    v_lshlrev_b32 v68, 16, v68
    v_mul_f32 v69, v68, v67
    v_fma_f32 v68, -v69, v66, v68
    v_fma_f32 v69, v68, v67, v69
    v_cvt_pk_bf16_f32 v37, v69, v69
    v_lshlrev_b32 v37, 16, v37
    v_sub_f32 v68, v28, v65
    v_cvt_pk_bf16_f32 v68, v68, v68
    v_lshlrev_b32 v68, 16, v68
    v_mul_f32 v69, v68, v67
    v_fma_f32 v68, -v69, v66, v68
    v_fma_f32 v69, v68, v67, v69
    v_cvt_pk_bf16_f32 v38, v69, v69
    v_lshlrev_b32 v38, 16, v38
    v_sub_f32 v68, v29, v65
    v_cvt_pk_bf16_f32 v68, v68, v68
    v_lshlrev_b32 v68, 16, v68
    v_mul_f32 v69, v68, v67
    v_fma_f32 v68, -v69, v66, v68
    v_fma_f32 v69, v68, v67, v69
    v_cvt_pk_bf16_f32 v39, v69, v69
    v_lshlrev_b32 v39, 16, v39
    v_sub_f32 v68, v30, v65
    v_cvt_pk_bf16_f32 v68, v68, v68
    v_lshlrev_b32 v68, 16, v68
    v_mul_f32 v69, v68, v67
    v_fma_f32 v68, -v69, v66, v68
    v_fma_f32 v69, v68, v67, v69
    v_cvt_pk_bf16_f32 v40, v69, v69
    v_lshlrev_b32 v40, 16, v40
    v_sub_f32 v68, v31, v65
    v_cvt_pk_bf16_f32 v68, v68, v68
    v_lshlrev_b32 v68, 16, v68
    v_mul_f32 v69, v68, v67
    v_fma_f32 v68, -v69, v66, v68
    v_fma_f32 v69, v68, v67, v69
    v_cvt_pk_bf16_f32 v41, v69, v69
    v_lshlrev_b32 v41, 16, v41
    v_sub_f32 v68, v32, v65
    v_cvt_pk_bf16_f32 v68, v68, v68
    v_lshlrev_b32 v68, 16, v68
    v_mul_f32 v69, v68, v67
    v_fma_f32 v68, -v69, v66, v68
    v_fma_f32 v69, v68, v67, v69
    v_cvt_pk_bf16_f32 v42, v69, v69
    v_lshlrev_b32 v42, 16, v42
    v_sub_f32 v68, v33, v65
    v_cvt_pk_bf16_f32 v68, v68, v68
    v_lshlrev_b32 v68, 16, v68
    v_mul_f32 v69, v68, v67
    v_fma_f32 v68, -v69, v66, v68
    v_fma_f32 v69, v68, v67, v69
    v_cvt_pk_bf16_f32 v43, v69, v69
    v_lshlrev_b32 v43, 16, v43
    s_mul_i32 s8, s3, 2560
    v_lshl_add_u32 v64, v1, 3, s8
    ds_write_b64 v64, v[24:25] offset:50560
    ds_write_b64 v64, v[26:27] offset:51072
    ds_write_b64 v64, v[28:29] offset:51584
    ds_write_b64 v64, v[30:31] offset:52096
    ds_write_b64 v64, v[32:33] offset:52608
    v_add_u32 v65, 71040, v64
    ds_write_b64 v65, v[34:35] offset:0
    ds_write_b64 v65, v[36:37] offset:512
    ds_write_b64 v65, v[38:39] offset:1024
    ds_write_b64 v65, v[40:41] offset:1536
    ds_write_b64 v65, v[42:43] offset:2048
    s_waitcnt lgkmcnt(0)
    v_lshl_add_u32 v64, v7, 2, s8
    ds_read_b32 v54, v64 offset:50560
    ds_read_b32 v55, v64 offset:50816
    ds_read_b32 v56, v64 offset:51072
    ds_read_b32 v57, v64 offset:51328
    ds_read_b32 v58, v64 offset:51584
    ds_read_b32 v59, v64 offset:51840
    ds_read_b32 v60, v64 offset:52096
    ds_read_b32 v61, v64 offset:52352
    ds_read_b32 v62, v64 offset:52608
    ds_read_b32 v63, v64 offset:52864
    s_cmp_ge_u32 s3, 4
    s_cbranch_scc1 K1_NOB
    s_lshl_b32 s9, s2, 2
    s_add_u32 s9, s9, s8
    s_add_u32 s9, s9, 71040
    v_mov_b32 v65, s9
    ds_read_b32 v34, v65 offset:0
    ds_read_b32 v35, v65 offset:1024
    s_cmp_lt_u32 s2, 128
    s_cselect_b32 s11, 2048, 0
    v_add_u32 v65, s11, v65
    ds_read_b32 v36, v65 offset:0
    s_waitcnt vmcnt(42)
    v_mov_b32 v43, 0xc0135761
    s_mov_b32 s12, 0xbdd2d3e8
    v_mov_b32 v37, 0
    v_mov_b32 v38, 0
    v_mov_b32 v39, 0
    s_waitcnt lgkmcnt(0)
    v_lshlrev_b32 v40, 16, v15
    v_lshlrev_b32 v41, 16, v18
    v_lshlrev_b32 v42, 16, v21
    v_mul_f32 v64, v34, v40
    v_cvt_pk_bf16_f32 v64, v64, v64
    v_lshlrev_b32 v64, 16, v64
    v_add_f32 v64, v64, v41
    v_cvt_pk_bf16_f32 v64, v64, v64
    v_lshlrev_b32 v64, 16, v64
    v_mul_f32 v65, v64, v64
    v_fma_f32 v65, v65, s12, v43
    v_mul_f32 v65, v65, v64
    v_exp_f32 v65, v65
    s_nop 0
    v_add_f32 v65, 1.0, v65
    v_rcp_f32 v65, v65
    s_nop 0
    v_mul_f32 v65, v65, v64
    v_cvt_pk_bf16_f32 v65, v65, v65
    v_lshlrev_b32 v65, 16, v65
    v_fmac_f32 v37, v65, v42
    v_mul_f32 v64, v35, v40
    v_cvt_pk_bf16_f32 v64, v64, v64
    v_lshlrev_b32 v64, 16, v64
    v_add_f32 v64, v64, v41
    v_cvt_pk_bf16_f32 v64, v64, v64
    v_lshlrev_b32 v64, 16, v64
    v_mul_f32 v65, v64, v64
    v_fma_f32 v65, v65, s12, v43
    v_mul_f32 v65, v65, v64
    v_exp_f32 v65, v65
    s_nop 0
    v_add_f32 v65, 1.0, v65
    v_rcp_f32 v65, v65
    s_nop 0
    v_mul_f32 v65, v65, v64
    v_cvt_pk_bf16_f32 v65, v65, v65
    v_lshlrev_b32 v65, 16, v65
    v_fmac_f32 v38, v65, v42
    v_mul_f32 v64, v36, v40
    v_cvt_pk_bf16_f32 v64, v64, v64
    v_lshlrev_b32 v64, 16, v64
    v_add_f32 v64, v64, v41
    v_cvt_pk_bf16_f32 v64, v64, v64
    v_lshlrev_b32 v64, 16, v64
    v_mul_f32 v65, v64, v64
    v_fma_f32 v65, v65, s12, v43
    v_mul_f32 v65, v65, v64
    v_exp_f32 v65, v65
    s_nop 0
    v_add_f32 v65, 1.0, v65
    v_rcp_f32 v65, v65
    s_nop 0
    v_mul_f32 v65, v65, v64
    v_cvt_pk_bf16_f32 v65, v65, v65
    v_lshlrev_b32 v65, 16, v65
    v_fmac_f32 v39, v65, v42
    v_and_b32 v40, 0xffff0000, v15
    v_and_b32 v41, 0xffff0000, v18
    v_and_b32 v42, 0xffff0000, v21
    v_mul_f32 v64, v34, v40
    v_cvt_pk_bf16_f32 v64, v64, v64
    v_lshlrev_b32 v64, 16, v64
    v_add_f32 v64, v64, v41
    v_cvt_pk_bf16_f32 v64, v64, v64
    v_lshlrev_b32 v64, 16, v64
    v_mul_f32 v65, v64, v64
    v_fma_f32 v65, v65, s12, v43
    v_mul_f32 v65, v65, v64
    v_exp_f32 v65, v65
    s_nop 0
    v_add_f32 v65, 1.0, v65
    v_rcp_f32 v65, v65
    s_nop 0
    v_mul_f32 v65, v65, v64
    v_cvt_pk_bf16_f32 v65, v65, v65
    v_lshlrev_b32 v65, 16, v65
    v_fmac_f32 v37, v65, v42
    v_mul_f32 v64, v35, v40
    v_cvt_pk_bf16_f32 v64, v64, v64
    v_lshlrev_b32 v64, 16, v64
    v_add_f32 v64, v64, v41
    v_cvt_pk_bf16_f32 v64, v64, v64
    v_lshlrev_b32 v64, 16, v64
    v_mul_f32 v65, v64, v64
    v_fma_f32 v65, v65, s12, v43
    v_mul_f32 v65, v65, v64
    v_exp_f32 v65, v65
    s_nop 0
    v_add_f32 v65, 1.0, v65
    v_rcp_f32 v65, v65
    s_nop 0
    v_mul_f32 v65, v65, v64
    v_cvt_pk_bf16_f32 v65, v65, v65
    v_lshlrev_b32 v65, 16, v65
    v_fmac_f32 v38, v65, v42
    v_mul_f32 v64, v36, v40
    v_cvt_pk_bf16_f32 v64, v64, v64
    v_lshlrev_b32 v64, 16, v64
    v_add_f32 v64, v64, v41
    v_cvt_pk_bf16_f32 v64, v64, v64
    v_lshlrev_b32 v64, 16, v64
    v_mul_f32 v65, v64, v64
    v_fma_f32 v65, v65, s12, v43
    v_mul_f32 v65, v65, v64
    v_exp_f32 v65, v65
    s_nop 0
    v_add_f32 v65, 1.0, v65
    v_rcp_f32 v65, v65
    s_nop 0
    v_mul_f32 v65, v65, v64
    v_cvt_pk_bf16_f32 v65, v65, v65
    v_lshlrev_b32 v65, 16, v65
    v_fmac_f32 v39, v65, v42
    v_lshlrev_b32 v40, 16, v16
    v_lshlrev_b32 v41, 16, v19
    v_lshlrev_b32 v42, 16, v22
    v_mul_f32 v64, v34, v40
    v_cvt_pk_bf16_f32 v64, v64, v64
    v_lshlrev_b32 v64, 16, v64
    v_add_f32 v64, v64, v41
    v_cvt_pk_bf16_f32 v64, v64, v64
    v_lshlrev_b32 v64, 16, v64
    v_mul_f32 v65, v64, v64
    v_fma_f32 v65, v65, s12, v43
    v_mul_f32 v65, v65, v64
    v_exp_f32 v65, v65
    s_nop 0
    v_add_f32 v65, 1.0, v65
    v_rcp_f32 v65, v65
    s_nop 0
    v_mul_f32 v65, v65, v64
    v_cvt_pk_bf16_f32 v65, v65, v65
    v_lshlrev_b32 v65, 16, v65
    v_fmac_f32 v37, v65, v42
    v_mul_f32 v64, v35, v40
    v_cvt_pk_bf16_f32 v64, v64, v64
    v_lshlrev_b32 v64, 16, v64
    v_add_f32 v64, v64, v41
    v_cvt_pk_bf16_f32 v64, v64, v64
    v_lshlrev_b32 v64, 16, v64
    v_mul_f32 v65, v64, v64
    v_fma_f32 v65, v65, s12, v43
    v_mul_f32 v65, v65, v64
    v_exp_f32 v65, v65
    s_nop 0
    v_add_f32 v65, 1.0, v65
    v_rcp_f32 v65, v65
    s_nop 0
    v_mul_f32 v65, v65, v64
    v_cvt_pk_bf16_f32 v65, v65, v65
    v_lshlrev_b32 v65, 16, v65
    v_fmac_f32 v38, v65, v42
    v_mul_f32 v64, v36, v40
    v_cvt_pk_bf16_f32 v64, v64, v64
    v_lshlrev_b32 v64, 16, v64
    v_add_f32 v64, v64, v41
    v_cvt_pk_bf16_f32 v64, v64, v64
    v_lshlrev_b32 v64, 16, v64
    v_mul_f32 v65, v64, v64
    v_fma_f32 v65, v65, s12, v43
    v_mul_f32 v65, v65, v64
    v_exp_f32 v65, v65
    s_nop 0
    v_add_f32 v65, 1.0, v65
    v_rcp_f32 v65, v65
    s_nop 0
    v_mul_f32 v65, v65, v64
    v_cvt_pk_bf16_f32 v65, v65, v65
    v_lshlrev_b32 v65, 16, v65
    v_fmac_f32 v39, v65, v42
    v_and_b32 v40, 0xffff0000, v16
    v_and_b32 v41, 0xffff0000, v19
    v_and_b32 v42, 0xffff0000, v22
    v_mul_f32 v64, v34, v40
    v_cvt_pk_bf16_f32 v64, v64, v64
    v_lshlrev_b32 v64, 16, v64
    v_add_f32 v64, v64, v41
    v_cvt_pk_bf16_f32 v64, v64, v64
    v_lshlrev_b32 v64, 16, v64
    v_mul_f32 v65, v64, v64
    v_fma_f32 v65, v65, s12, v43
    v_mul_f32 v65, v65, v64
    v_exp_f32 v65, v65
    s_nop 0
    v_add_f32 v65, 1.0, v65
    v_rcp_f32 v65, v65
    s_nop 0
    v_mul_f32 v65, v65, v64
    v_cvt_pk_bf16_f32 v65, v65, v65
    v_lshlrev_b32 v65, 16, v65
    v_fmac_f32 v37, v65, v42
    v_mul_f32 v64, v35, v40
    v_cvt_pk_bf16_f32 v64, v64, v64
    v_lshlrev_b32 v64, 16, v64
    v_add_f32 v64, v64, v41
    v_cvt_pk_bf16_f32 v64, v64, v64
    v_lshlrev_b32 v64, 16, v64
    v_mul_f32 v65, v64, v64
    v_fma_f32 v65, v65, s12, v43
    v_mul_f32 v65, v65, v64
    v_exp_f32 v65, v65
    s_nop 0
    v_add_f32 v65, 1.0, v65
    v_rcp_f32 v65, v65
    s_nop 0
    v_mul_f32 v65, v65, v64
    v_cvt_pk_bf16_f32 v65, v65, v65
    v_lshlrev_b32 v65, 16, v65
    v_fmac_f32 v38, v65, v42
    v_mul_f32 v64, v36, v40
    v_cvt_pk_bf16_f32 v64, v64, v64
    v_lshlrev_b32 v64, 16, v64
    v_add_f32 v64, v64, v41
    v_cvt_pk_bf16_f32 v64, v64, v64
    v_lshlrev_b32 v64, 16, v64
    v_mul_f32 v65, v64, v64
    v_fma_f32 v65, v65, s12, v43
    v_mul_f32 v65, v65, v64
    v_exp_f32 v65, v65
    s_nop 0
    v_add_f32 v65, 1.0, v65
    v_rcp_f32 v65, v65
    s_nop 0
    v_mul_f32 v65, v65, v64
    v_cvt_pk_bf16_f32 v65, v65, v65
    v_lshlrev_b32 v65, 16, v65
    v_fmac_f32 v39, v65, v42
    v_lshlrev_b32 v40, 16, v17
    v_lshlrev_b32 v41, 16, v20
    v_lshlrev_b32 v42, 16, v23
    v_mul_f32 v64, v34, v40
    v_cvt_pk_bf16_f32 v64, v64, v64
    v_lshlrev_b32 v64, 16, v64
    v_add_f32 v64, v64, v41
    v_cvt_pk_bf16_f32 v64, v64, v64
    v_lshlrev_b32 v64, 16, v64
    v_mul_f32 v65, v64, v64
    v_fma_f32 v65, v65, s12, v43
    v_mul_f32 v65, v65, v64
    v_exp_f32 v65, v65
    s_nop 0
    v_add_f32 v65, 1.0, v65
    v_rcp_f32 v65, v65
    s_nop 0
    v_mul_f32 v65, v65, v64
    v_cvt_pk_bf16_f32 v65, v65, v65
    v_lshlrev_b32 v65, 16, v65
    v_fmac_f32 v37, v65, v42
    v_mul_f32 v64, v35, v40
    v_cvt_pk_bf16_f32 v64, v64, v64
    v_lshlrev_b32 v64, 16, v64
    v_add_f32 v64, v64, v41
    v_cvt_pk_bf16_f32 v64, v64, v64
    v_lshlrev_b32 v64, 16, v64
    v_mul_f32 v65, v64, v64
    v_fma_f32 v65, v65, s12, v43
    v_mul_f32 v65, v65, v64
    v_exp_f32 v65, v65
    s_nop 0
    v_add_f32 v65, 1.0, v65
    v_rcp_f32 v65, v65
    s_nop 0
    v_mul_f32 v65, v65, v64
    v_cvt_pk_bf16_f32 v65, v65, v65
    v_lshlrev_b32 v65, 16, v65
    v_fmac_f32 v38, v65, v42
    v_mul_f32 v64, v36, v40
    v_cvt_pk_bf16_f32 v64, v64, v64
    v_lshlrev_b32 v64, 16, v64
    v_add_f32 v64, v64, v41
    v_cvt_pk_bf16_f32 v64, v64, v64
    v_lshlrev_b32 v64, 16, v64
    v_mul_f32 v65, v64, v64
    v_fma_f32 v65, v65, s12, v43
    v_mul_f32 v65, v65, v64
    v_exp_f32 v65, v65
    s_nop 0
    v_add_f32 v65, 1.0, v65
    v_rcp_f32 v65, v65
    s_nop 0
    v_mul_f32 v65, v65, v64
    v_cvt_pk_bf16_f32 v65, v65, v65
    v_lshlrev_b32 v65, 16, v65
    v_fmac_f32 v39, v65, v42
    v_and_b32 v40, 0xffff0000, v17
    v_and_b32 v41, 0xffff0000, v20
    v_and_b32 v42, 0xffff0000, v23
    v_mul_f32 v64, v34, v40
    v_cvt_pk_bf16_f32 v64, v64, v64
    v_lshlrev_b32 v64, 16, v64
    v_add_f32 v64, v64, v41
    v_cvt_pk_bf16_f32 v64, v64, v64
    v_lshlrev_b32 v64, 16, v64
    v_mul_f32 v65, v64, v64
    v_fma_f32 v65, v65, s12, v43
    v_mul_f32 v65, v65, v64
    v_exp_f32 v65, v65
    s_nop 0
    v_add_f32 v65, 1.0, v65
    v_rcp_f32 v65, v65
    s_nop 0
    v_mul_f32 v65, v65, v64
    v_cvt_pk_bf16_f32 v65, v65, v65
    v_lshlrev_b32 v65, 16, v65
    v_fmac_f32 v37, v65, v42
    v_mul_f32 v64, v35, v40
    v_cvt_pk_bf16_f32 v64, v64, v64
    v_lshlrev_b32 v64, 16, v64
    v_add_f32 v64, v64, v41
    v_cvt_pk_bf16_f32 v64, v64, v64
    v_lshlrev_b32 v64, 16, v64
    v_mul_f32 v65, v64, v64
    v_fma_f32 v65, v65, s12, v43
    v_mul_f32 v65, v65, v64
    v_exp_f32 v65, v65
    s_nop 0
    v_add_f32 v65, 1.0, v65
    v_rcp_f32 v65, v65
    s_nop 0
    v_mul_f32 v65, v65, v64
    v_cvt_pk_bf16_f32 v65, v65, v65
    v_lshlrev_b32 v65, 16, v65
    v_fmac_f32 v38, v65, v42
    v_mul_f32 v64, v36, v40
    v_cvt_pk_bf16_f32 v64, v64, v64
    v_lshlrev_b32 v64, 16, v64
    v_add_f32 v64, v64, v41
    v_cvt_pk_bf16_f32 v64, v64, v64
    v_lshlrev_b32 v64, 16, v64
    v_mul_f32 v65, v64, v64
    v_fma_f32 v65, v65, s12, v43
    v_mul_f32 v65, v65, v64
    v_exp_f32 v65, v65
    s_nop 0
    v_add_f32 v65, 1.0, v65
    v_rcp_f32 v65, v65
    s_nop 0
    v_mul_f32 v65, v65, v64
    v_cvt_pk_bf16_f32 v65, v65, v65
    v_lshlrev_b32 v65, 16, v65
    v_fmac_f32 v39, v65, v42
    s_nop 1
    v_add_f32_dpp v37, v37, v37 quad_perm:[1,0,3,2] row_mask:0xf bank_mask:0xf
    s_nop 1
    v_add_f32_dpp v37, v37, v37 quad_perm:[2,3,0,1] row_mask:0xf bank_mask:0xf
    s_nop 1
    v_add_f32_dpp v37, v37, v37 row_half_mirror row_mask:0xf bank_mask:0xf
    s_nop 1
    v_add_f32_dpp v37, v37, v37 row_mirror row_mask:0xf bank_mask:0xf
    s_nop 1
    v_readlane_b32 s80, v37, 0
    v_readlane_b32 s81, v37, 16
    v_readlane_b32 s82, v37, 32
    v_readlane_b32 s83, v37, 48
    s_nop 1
    v_mov_b32 v37, s80
    v_add_f32 v37, s81, v37
    v_add_f32 v37, s82, v37
    v_add_f32 v37, s83, v37
    s_nop 1
    v_add_f32_dpp v38, v38, v38 quad_perm:[1,0,3,2] row_mask:0xf bank_mask:0xf
    s_nop 1
    v_add_f32_dpp v38, v38, v38 quad_perm:[2,3,0,1] row_mask:0xf bank_mask:0xf
    s_nop 1
    v_add_f32_dpp v38, v38, v38 row_half_mirror row_mask:0xf bank_mask:0xf
    s_nop 1
    v_add_f32_dpp v38, v38, v38 row_mirror row_mask:0xf bank_mask:0xf
    s_nop 1
    v_readlane_b32 s80, v38, 0
    v_readlane_b32 s81, v38, 16
    v_readlane_b32 s82, v38, 32
    v_readlane_b32 s83, v38, 48
    s_nop 1
    v_mov_b32 v38, s80
    v_add_f32 v38, s81, v38
    v_add_f32 v38, s82, v38
    v_add_f32 v38, s83, v38
    s_nop 1
    v_add_f32_dpp v39, v39, v39 quad_perm:[1,0,3,2] row_mask:0xf bank_mask:0xf
    s_nop 1
    v_add_f32_dpp v39, v39, v39 quad_perm:[2,3,0,1] row_mask:0xf bank_mask:0xf
    s_nop 1
    v_add_f32_dpp v39, v39, v39 row_half_mirror row_mask:0xf bank_mask:0xf
    s_nop 1
    v_add_f32_dpp v39, v39, v39 row_mirror row_mask:0xf bank_mask:0xf
    s_nop 1
    v_readlane_b32 s80, v39, 0
    v_readlane_b32 s81, v39, 16
    v_readlane_b32 s82, v39, 32
    v_readlane_b32 s83, v39, 48
    s_nop 1
    v_mov_b32 v39, s80
    v_add_f32 v39, s81, v39
    v_add_f32 v39, s82, v39
    v_add_f32 v39, s83, v39
    s_mul_i32 s8, s3, 12
    v_mov_b32 v64, s8
    s_mov_b64 s[14:15], exec
    s_mov_b64 exec, 1
    ds_write_b32 v64, v37 offset:50048
    ds_write_b32 v64, v38 offset:50052
    ds_write_b32 v64, v39 offset:50056
    s_mov_b64 exec, s[14:15]
K1_NOB:
    s_waitcnt lgkmcnt(0)
    v_mov_b32 v10, 0
    v_mov_b32 v11, 0
    v_mov_b32 v12, 0
    v_mov_b32 v13, 0
    v_mov_b32 v14, 0
    v_mov_b32 v15, 0
    v_mov_b32 v16, 0
    v_mov_b32 v17, 0
    v_mov_b32 v18, 0
    v_mov_b32 v19, 0
    v_mov_b32 v20, 0
    v_mov_b32 v21, 0
    v_mov_b32 v22, 0
    v_mov_b32 v23, 0
    v_mov_b32 v24, 0
    v_mov_b32 v25, 0
    v_mov_b32 v26, 0
    v_mov_b32 v27, 0
    v_mov_b32 v28, 0
    v_mov_b32 v29, 0
    v_mov_b32 v30, 0
    v_mov_b32 v31, 0
    v_mov_b32 v32, 0
    v_mov_b32 v33, 0
    s_waitcnt vmcnt(39)
    v_lshlrev_b32 v64, 16, v88
    v_and_b32 v65, 0xffff0000, v88
    v_fmac_f32 v10, v54, v64
    v_fmac_f32 v11, v54, v65
    v_lshlrev_b32 v64, 16, v89
    v_and_b32 v65, 0xffff0000, v89
    v_fmac_f32 v12, v54, v64
    v_fmac_f32 v13, v54, v65
    v_lshlrev_b32 v64, 16, v90
    v_and_b32 v65, 0xffff0000, v90
    v_fmac_f32 v14, v54, v64
    v_fmac_f32 v15, v54, v65
    v_lshlrev_b32 v64, 16, v91
    v_and_b32 v65, 0xffff0000, v91
    v_fmac_f32 v16, v54, v64
    v_fmac_f32 v17, v54, v65
    v_lshlrev_b32 v64, 16, v92
    v_and_b32 v65, 0xffff0000, v92
    v_fmac_f32 v18, v54, v64
    v_fmac_f32 v19, v54, v65
    v_lshlrev_b32 v64, 16, v93
    v_and_b32 v65, 0xffff0000, v93
    v_fmac_f32 v20, v54, v64
    v_fmac_f32 v21, v54, v65
    v_lshlrev_b32 v64, 16, v94
    v_and_b32 v65, 0xffff0000, v94
    v_fmac_f32 v22, v54, v64
    v_fmac_f32 v23, v54, v65
    v_lshlrev_b32 v64, 16, v95
    v_and_b32 v65, 0xffff0000, v95
    v_fmac_f32 v24, v54, v64
    v_fmac_f32 v25, v54, v65
    v_lshlrev_b32 v64, 16, v96
    v_and_b32 v65, 0xffff0000, v96
    v_fmac_f32 v26, v54, v64
    v_fmac_f32 v27, v54, v65
    v_lshlrev_b32 v64, 16, v97
    v_and_b32 v65, 0xffff0000, v97
    v_fmac_f32 v28, v54, v64
    v_fmac_f32 v29, v54, v65
    v_lshlrev_b32 v64, 16, v98
    v_and_b32 v65, 0xffff0000, v98
    v_fmac_f32 v30, v54, v64
    v_fmac_f32 v31, v54, v65
    v_lshlrev_b32 v64, 16, v99
    v_and_b32 v65, 0xffff0000, v99
    v_fmac_f32 v32, v54, v64
    v_fmac_f32 v33, v54, v65
    s_mov_b32 s10, 5505024
    buffer_load_dwordx4 v[88:91], v6, s[56:59], s10 offen offset:0 nt
    buffer_load_dwordx4 v[92:95], v6, s[56:59], s10 offen offset:128 nt
    buffer_load_dwordx4 v[96:99], v6, s[56:59], s10 offen offset:256 nt
    s_waitcnt vmcnt(36)
    v_lshlrev_b32 v64, 16, v112
    v_and_b32 v65, 0xffff0000, v112
    v_fmac_f32 v10, v55, v64
    v_fmac_f32 v11, v55, v65
    v_lshlrev_b32 v64, 16, v113
    v_and_b32 v65, 0xffff0000, v113
    v_fmac_f32 v12, v55, v64
    v_fmac_f32 v13, v55, v65
    v_lshlrev_b32 v64, 16, v114
    v_and_b32 v65, 0xffff0000, v114
    v_fmac_f32 v14, v55, v64
    v_fmac_f32 v15, v55, v65
    v_lshlrev_b32 v64, 16, v115
    v_and_b32 v65, 0xffff0000, v115
    v_fmac_f32 v16, v55, v64
    v_fmac_f32 v17, v55, v65
    v_lshlrev_b32 v64, 16, v116
    v_and_b32 v65, 0xffff0000, v116
    v_fmac_f32 v18, v55, v64
    v_fmac_f32 v19, v55, v65
    v_lshlrev_b32 v64, 16, v117
    v_and_b32 v65, 0xffff0000, v117
    v_fmac_f32 v20, v55, v64
    v_fmac_f32 v21, v55, v65
    v_lshlrev_b32 v64, 16, v118
    v_and_b32 v65, 0xffff0000, v118
    v_fmac_f32 v22, v55, v64
    v_fmac_f32 v23, v55, v65
    v_lshlrev_b32 v64, 16, v119
    v_and_b32 v65, 0xffff0000, v119
    v_fmac_f32 v24, v55, v64
    v_fmac_f32 v25, v55, v65
    v_lshlrev_b32 v64, 16, v120
    v_and_b32 v65, 0xffff0000, v120
    v_fmac_f32 v26, v55, v64
    v_fmac_f32 v27, v55, v65
    v_lshlrev_b32 v64, 16, v121
    v_and_b32 v65, 0xffff0000, v121
    v_fmac_f32 v28, v55, v64
    v_fmac_f32 v29, v55, v65
    v_lshlrev_b32 v64, 16, v122
    v_and_b32 v65, 0xffff0000, v122
    v_fmac_f32 v30, v55, v64
    v_fmac_f32 v31, v55, v65
    v_lshlrev_b32 v64, 16, v123
    v_and_b32 v65, 0xffff0000, v123
    v_fmac_f32 v32, v55, v64
    v_fmac_f32 v33, v55, v65
    s_mov_b32 s10, 21504
    buffer_load_dwordx4 v[112:115], v5, s[48:51], s10 offen offset:0 nt
    buffer_load_dwordx4 v[116:119], v5, s[48:51], s10 offen offset:128 nt
    buffer_load_dwordx4 v[120:123], v5, s[48:51], s10 offen offset:256 nt
    s_waitcnt vmcnt(33)
    v_lshlrev_b32 v64, 16, v136
    v_and_b32 v65, 0xffff0000, v136
    v_fmac_f32 v10, v56, v64
    v_fmac_f32 v11, v56, v65
    v_lshlrev_b32 v64, 16, v137
    v_and_b32 v65, 0xffff0000, v137
    v_fmac_f32 v12, v56, v64
    v_fmac_f32 v13, v56, v65
    v_lshlrev_b32 v64, 16, v138
    v_and_b32 v65, 0xffff0000, v138
    v_fmac_f32 v14, v56, v64
    v_fmac_f32 v15, v56, v65
    v_lshlrev_b32 v64, 16, v139
    v_and_b32 v65, 0xffff0000, v139
    v_fmac_f32 v16, v56, v64
    v_fmac_f32 v17, v56, v65
    v_lshlrev_b32 v64, 16, v140
    v_and_b32 v65, 0xffff0000, v140
    v_fmac_f32 v18, v56, v64
    v_fmac_f32 v19, v56, v65
    v_lshlrev_b32 v64, 16, v141
    v_and_b32 v65, 0xffff0000, v141
    v_fmac_f32 v20, v56, v64
    v_fmac_f32 v21, v56, v65
    v_lshlrev_b32 v64, 16, v142
    v_and_b32 v65, 0xffff0000, v142
    v_fmac_f32 v22, v56, v64
    v_fmac_f32 v23, v56, v65
    v_lshlrev_b32 v64, 16, v143
    v_and_b32 v65, 0xffff0000, v143
    v_fmac_f32 v24, v56, v64
    v_fmac_f32 v25, v56, v65
    v_lshlrev_b32 v64, 16, v144
    v_and_b32 v65, 0xffff0000, v144
    v_fmac_f32 v26, v56, v64
    v_fmac_f32 v27, v56, v65
    v_lshlrev_b32 v64, 16, v145
    v_and_b32 v65, 0xffff0000, v145
    v_fmac_f32 v28, v56, v64
    v_fmac_f32 v29, v56, v65
    v_lshlrev_b32 v64, 16, v146
    v_and_b32 v65, 0xffff0000, v146
    v_fmac_f32 v30, v56, v64
    v_fmac_f32 v31, v56, v65
    v_lshlrev_b32 v64, 16, v147
    v_and_b32 v65, 0xffff0000, v147
    v_fmac_f32 v32, v56, v64
    v_fmac_f32 v33, v56, v65
    s_mov_b32 s10, 6291456
    buffer_load_dwordx4 v[136:139], v6, s[56:59], s10 offen offset:0 nt
    buffer_load_dwordx4 v[140:143], v6, s[56:59], s10 offen offset:128 nt
    buffer_load_dwordx4 v[144:147], v6, s[56:59], s10 offen offset:256 nt
    s_waitcnt vmcnt(30)
    v_lshlrev_b32 v64, 16, v160
    v_and_b32 v65, 0xffff0000, v160
    v_fmac_f32 v10, v57, v64
    v_fmac_f32 v11, v57, v65
    v_lshlrev_b32 v64, 16, v161
    v_and_b32 v65, 0xffff0000, v161
    v_fmac_f32 v12, v57, v64
    v_fmac_f32 v13, v57, v65
    v_lshlrev_b32 v64, 16, v162
    v_and_b32 v65, 0xffff0000, v162
    v_fmac_f32 v14, v57, v64
    v_fmac_f32 v15, v57, v65
    v_lshlrev_b32 v64, 16, v163
    v_and_b32 v65, 0xffff0000, v163
    v_fmac_f32 v16, v57, v64
    v_fmac_f32 v17, v57, v65
    v_lshlrev_b32 v64, 16, v164
    v_and_b32 v65, 0xffff0000, v164
    v_fmac_f32 v18, v57, v64
    v_fmac_f32 v19, v57, v65
    v_lshlrev_b32 v64, 16, v165
    v_and_b32 v65, 0xffff0000, v165
    v_fmac_f32 v20, v57, v64
    v_fmac_f32 v21, v57, v65
    v_lshlrev_b32 v64, 16, v166
    v_and_b32 v65, 0xffff0000, v166
    v_fmac_f32 v22, v57, v64
    v_fmac_f32 v23, v57, v65
    v_lshlrev_b32 v64, 16, v167
    v_and_b32 v65, 0xffff0000, v167
    v_fmac_f32 v24, v57, v64
    v_fmac_f32 v25, v57, v65
    v_lshlrev_b32 v64, 16, v168
    v_and_b32 v65, 0xffff0000, v168
    v_fmac_f32 v26, v57, v64
    v_fmac_f32 v27, v57, v65
    v_lshlrev_b32 v64, 16, v169
    v_and_b32 v65, 0xffff0000, v169
    v_fmac_f32 v28, v57, v64
    v_fmac_f32 v29, v57, v65
    v_lshlrev_b32 v64, 16, v170
    v_and_b32 v65, 0xffff0000, v170
    v_fmac_f32 v30, v57, v64
    v_fmac_f32 v31, v57, v65
    v_lshlrev_b32 v64, 16, v171
    v_and_b32 v65, 0xffff0000, v171
    v_fmac_f32 v32, v57, v64
    v_fmac_f32 v33, v57, v65
    s_mov_b32 s10, 0
    buffer_load_dwordx4 v[160:163], v5, s[52:55], s10 offen offset:0 nt
    buffer_load_dwordx4 v[164:167], v5, s[52:55], s10 offen offset:128 nt
    buffer_load_dwordx4 v[168:171], v5, s[52:55], s10 offen offset:256 nt
    s_waitcnt vmcnt(27)
    v_lshlrev_b32 v64, 16, v184
    v_and_b32 v65, 0xffff0000, v184
    v_fmac_f32 v10, v58, v64
    v_fmac_f32 v11, v58, v65
    v_lshlrev_b32 v64, 16, v185
    v_and_b32 v65, 0xffff0000, v185
    v_fmac_f32 v12, v58, v64
    v_fmac_f32 v13, v58, v65
    v_lshlrev_b32 v64, 16, v186
    v_and_b32 v65, 0xffff0000, v186
    v_fmac_f32 v14, v58, v64
    v_fmac_f32 v15, v58, v65
    v_lshlrev_b32 v64, 16, v187
    v_and_b32 v65, 0xffff0000, v187
    v_fmac_f32 v16, v58, v64
    v_fmac_f32 v17, v58, v65
    v_lshlrev_b32 v64, 16, v188
    v_and_b32 v65, 0xffff0000, v188
    v_fmac_f32 v18, v58, v64
    v_fmac_f32 v19, v58, v65
    v_lshlrev_b32 v64, 16, v189
    v_and_b32 v65, 0xffff0000, v189
    v_fmac_f32 v20, v58, v64
    v_fmac_f32 v21, v58, v65
    v_lshlrev_b32 v64, 16, v190
    v_and_b32 v65, 0xffff0000, v190
    v_fmac_f32 v22, v58, v64
    v_fmac_f32 v23, v58, v65
    v_lshlrev_b32 v64, 16, v191
    v_and_b32 v65, 0xffff0000, v191
    v_fmac_f32 v24, v58, v64
    v_fmac_f32 v25, v58, v65
    v_lshlrev_b32 v64, 16, v192
    v_and_b32 v65, 0xffff0000, v192
    v_fmac_f32 v26, v58, v64
    v_fmac_f32 v27, v58, v65
    v_lshlrev_b32 v64, 16, v193
    v_and_b32 v65, 0xffff0000, v193
    v_fmac_f32 v28, v58, v64
    v_fmac_f32 v29, v58, v65
    v_lshlrev_b32 v64, 16, v194
    v_and_b32 v65, 0xffff0000, v194
    v_fmac_f32 v30, v58, v64
    v_fmac_f32 v31, v58, v65
    v_lshlrev_b32 v64, 16, v195
    v_and_b32 v65, 0xffff0000, v195
    v_fmac_f32 v32, v58, v64
    v_fmac_f32 v33, v58, v65
    s_mov_b32 s10, 7077888
    buffer_load_dwordx4 v[184:187], v6, s[56:59], s10 offen offset:0 nt
    buffer_load_dwordx4 v[188:191], v6, s[56:59], s10 offen offset:128 nt
    buffer_load_dwordx4 v[192:195], v6, s[56:59], s10 offen offset:256 nt
    s_waitcnt vmcnt(24)
    v_lshlrev_b32 v64, 16, v208
    v_and_b32 v65, 0xffff0000, v208
    v_fmac_f32 v10, v59, v64
    v_fmac_f32 v11, v59, v65
    v_lshlrev_b32 v64, 16, v209
    v_and_b32 v65, 0xffff0000, v209
    v_fmac_f32 v12, v59, v64
    v_fmac_f32 v13, v59, v65
    v_lshlrev_b32 v64, 16, v210
    v_and_b32 v65, 0xffff0000, v210
    v_fmac_f32 v14, v59, v64
    v_fmac_f32 v15, v59, v65
    v_lshlrev_b32 v64, 16, v211
    v_and_b32 v65, 0xffff0000, v211
    v_fmac_f32 v16, v59, v64
    v_fmac_f32 v17, v59, v65
    v_lshlrev_b32 v64, 16, v212
    v_and_b32 v65, 0xffff0000, v212
    v_fmac_f32 v18, v59, v64
    v_fmac_f32 v19, v59, v65
    v_lshlrev_b32 v64, 16, v213
    v_and_b32 v65, 0xffff0000, v213
    v_fmac_f32 v20, v59, v64
    v_fmac_f32 v21, v59, v65
    v_lshlrev_b32 v64, 16, v214
    v_and_b32 v65, 0xffff0000, v214
    v_fmac_f32 v22, v59, v64
    v_fmac_f32 v23, v59, v65
    v_lshlrev_b32 v64, 16, v215
    v_and_b32 v65, 0xffff0000, v215
    v_fmac_f32 v24, v59, v64
    v_fmac_f32 v25, v59, v65
    v_lshlrev_b32 v64, 16, v216
    v_and_b32 v65, 0xffff0000, v216
    v_fmac_f32 v26, v59, v64
    v_fmac_f32 v27, v59, v65
    v_lshlrev_b32 v64, 16, v217
    v_and_b32 v65, 0xffff0000, v217
    v_fmac_f32 v28, v59, v64
    v_fmac_f32 v29, v59, v65
    v_lshlrev_b32 v64, 16, v218
    v_and_b32 v65, 0xffff0000, v218
    v_fmac_f32 v30, v59, v64
    v_fmac_f32 v31, v59, v65
    v_lshlrev_b32 v64, 16, v219
    v_and_b32 v65, 0xffff0000, v219
    v_fmac_f32 v32, v59, v64
    v_fmac_f32 v33, v59, v65
    s_mov_b32 s10, 3072
    buffer_load_dwordx4 v[208:211], v5, s[52:55], s10 offen offset:0 nt
    buffer_load_dwordx4 v[212:215], v5, s[52:55], s10 offen offset:128 nt
    buffer_load_dwordx4 v[216:219], v5, s[52:55], s10 offen offset:256 nt
    s_waitcnt vmcnt(21)
    v_lshlrev_b32 v64, 16, v232
    v_and_b32 v65, 0xffff0000, v232
    v_fmac_f32 v10, v60, v64
    v_fmac_f32 v11, v60, v65
    v_lshlrev_b32 v64, 16, v233
    v_and_b32 v65, 0xffff0000, v233
    v_fmac_f32 v12, v60, v64
    v_fmac_f32 v13, v60, v65
    v_lshlrev_b32 v64, 16, v234
    v_and_b32 v65, 0xffff0000, v234
    v_fmac_f32 v14, v60, v64
    v_fmac_f32 v15, v60, v65
    v_lshlrev_b32 v64, 16, v235
    v_and_b32 v65, 0xffff0000, v235
    v_fmac_f32 v16, v60, v64
    v_fmac_f32 v17, v60, v65
    v_lshlrev_b32 v64, 16, v236
    v_and_b32 v65, 0xffff0000, v236
    v_fmac_f32 v18, v60, v64
    v_fmac_f32 v19, v60, v65
    v_lshlrev_b32 v64, 16, v237
    v_and_b32 v65, 0xffff0000, v237
    v_fmac_f32 v20, v60, v64
    v_fmac_f32 v21, v60, v65
    v_lshlrev_b32 v64, 16, v238
    v_and_b32 v65, 0xffff0000, v238
    v_fmac_f32 v22, v60, v64
    v_fmac_f32 v23, v60, v65
    v_lshlrev_b32 v64, 16, v239
    v_and_b32 v65, 0xffff0000, v239
    v_fmac_f32 v24, v60, v64
    v_fmac_f32 v25, v60, v65
    v_lshlrev_b32 v64, 16, v240
    v_and_b32 v65, 0xffff0000, v240
    v_fmac_f32 v26, v60, v64
    v_fmac_f32 v27, v60, v65
    v_lshlrev_b32 v64, 16, v241
    v_and_b32 v65, 0xffff0000, v241
    v_fmac_f32 v28, v60, v64
    v_fmac_f32 v29, v60, v65
    v_lshlrev_b32 v64, 16, v242
    v_and_b32 v65, 0xffff0000, v242
    v_fmac_f32 v30, v60, v64
    v_fmac_f32 v31, v60, v65
    v_lshlrev_b32 v64, 16, v243
    v_and_b32 v65, 0xffff0000, v243
    v_fmac_f32 v32, v60, v64
    v_fmac_f32 v33, v60, v65
    s_mov_b32 s10, 6144
    buffer_load_dwordx4 v[232:235], v5, s[52:55], s10 offen offset:0 nt
    buffer_load_dwordx4 v[236:239], v5, s[52:55], s10 offen offset:128 nt
    buffer_load_dwordx4 v[240:243], v5, s[52:55], s10 offen offset:256 nt
    s_waitcnt vmcnt(18)
    v_lshlrev_b32 v64, 16, v88
    v_and_b32 v65, 0xffff0000, v88
    v_fmac_f32 v10, v61, v64
    v_fmac_f32 v11, v61, v65
    v_lshlrev_b32 v64, 16, v89
    v_and_b32 v65, 0xffff0000, v89
    v_fmac_f32 v12, v61, v64
    v_fmac_f32 v13, v61, v65
    v_lshlrev_b32 v64, 16, v90
    v_and_b32 v65, 0xffff0000, v90
    v_fmac_f32 v14, v61, v64
    v_fmac_f32 v15, v61, v65
    v_lshlrev_b32 v64, 16, v91
    v_and_b32 v65, 0xffff0000, v91
    v_fmac_f32 v16, v61, v64
    v_fmac_f32 v17, v61, v65
    v_lshlrev_b32 v64, 16, v92
    v_and_b32 v65, 0xffff0000, v92
    v_fmac_f32 v18, v61, v64
    v_fmac_f32 v19, v61, v65
    v_lshlrev_b32 v64, 16, v93
    v_and_b32 v65, 0xffff0000, v93
    v_fmac_f32 v20, v61, v64
    v_fmac_f32 v21, v61, v65
    v_lshlrev_b32 v64, 16, v94
    v_and_b32 v65, 0xffff0000, v94
    v_fmac_f32 v22, v61, v64
    v_fmac_f32 v23, v61, v65
    v_lshlrev_b32 v64, 16, v95
    v_and_b32 v65, 0xffff0000, v95
    v_fmac_f32 v24, v61, v64
    v_fmac_f32 v25, v61, v65
    v_lshlrev_b32 v64, 16, v96
    v_and_b32 v65, 0xffff0000, v96
    v_fmac_f32 v26, v61, v64
    v_fmac_f32 v27, v61, v65
    v_lshlrev_b32 v64, 16, v97
    v_and_b32 v65, 0xffff0000, v97
    v_fmac_f32 v28, v61, v64
    v_fmac_f32 v29, v61, v65
    v_lshlrev_b32 v64, 16, v98
    v_and_b32 v65, 0xffff0000, v98
    v_fmac_f32 v30, v61, v64
    v_fmac_f32 v31, v61, v65
    v_lshlrev_b32 v64, 16, v99
    v_and_b32 v65, 0xffff0000, v99
    v_fmac_f32 v32, v61, v64
    v_fmac_f32 v33, v61, v65
    s_mov_b32 s10, 9216
    buffer_load_dwordx4 v[88:91], v5, s[52:55], s10 offen offset:0 nt
    buffer_load_dwordx4 v[92:95], v5, s[52:55], s10 offen offset:128 nt
    buffer_load_dwordx4 v[96:99], v5, s[52:55], s10 offen offset:256 nt
    s_waitcnt vmcnt(15)
    v_lshlrev_b32 v64, 16, v136
    v_and_b32 v65, 0xffff0000, v136
    v_fmac_f32 v10, v62, v64
    v_fmac_f32 v11, v62, v65
    v_lshlrev_b32 v64, 16, v137
    v_and_b32 v65, 0xffff0000, v137
    v_fmac_f32 v12, v62, v64
    v_fmac_f32 v13, v62, v65
    v_lshlrev_b32 v64, 16, v138
    v_and_b32 v65, 0xffff0000, v138
    v_fmac_f32 v14, v62, v64
    v_fmac_f32 v15, v62, v65
    v_lshlrev_b32 v64, 16, v139
    v_and_b32 v65, 0xffff0000, v139
    v_fmac_f32 v16, v62, v64
    v_fmac_f32 v17, v62, v65
    v_lshlrev_b32 v64, 16, v140
    v_and_b32 v65, 0xffff0000, v140
    v_fmac_f32 v18, v62, v64
    v_fmac_f32 v19, v62, v65
    v_lshlrev_b32 v64, 16, v141
    v_and_b32 v65, 0xffff0000, v141
    v_fmac_f32 v20, v62, v64
    v_fmac_f32 v21, v62, v65
    v_lshlrev_b32 v64, 16, v142
    v_and_b32 v65, 0xffff0000, v142
    v_fmac_f32 v22, v62, v64
    v_fmac_f32 v23, v62, v65
    v_lshlrev_b32 v64, 16, v143
    v_and_b32 v65, 0xffff0000, v143
    v_fmac_f32 v24, v62, v64
    v_fmac_f32 v25, v62, v65
    v_lshlrev_b32 v64, 16, v144
    v_and_b32 v65, 0xffff0000, v144
    v_fmac_f32 v26, v62, v64
    v_fmac_f32 v27, v62, v65
    v_lshlrev_b32 v64, 16, v145
    v_and_b32 v65, 0xffff0000, v145
    v_fmac_f32 v28, v62, v64
    v_fmac_f32 v29, v62, v65
    v_lshlrev_b32 v64, 16, v146
    v_and_b32 v65, 0xffff0000, v146
    v_fmac_f32 v30, v62, v64
    v_fmac_f32 v31, v62, v65
    v_lshlrev_b32 v64, 16, v147
    v_and_b32 v65, 0xffff0000, v147
    v_fmac_f32 v32, v62, v64
    v_fmac_f32 v33, v62, v65
    s_mov_b32 s10, 12288
    buffer_load_dwordx4 v[136:139], v5, s[52:55], s10 offen offset:0 nt
    buffer_load_dwordx4 v[140:143], v5, s[52:55], s10 offen offset:128 nt
    buffer_load_dwordx4 v[144:147], v5, s[52:55], s10 offen offset:256 nt
    s_waitcnt vmcnt(12)
    v_lshlrev_b32 v64, 16, v184
    v_and_b32 v65, 0xffff0000, v184
    v_fmac_f32 v10, v63, v64
    v_fmac_f32 v11, v63, v65
    v_lshlrev_b32 v64, 16, v185
    v_and_b32 v65, 0xffff0000, v185
    v_fmac_f32 v12, v63, v64
    v_fmac_f32 v13, v63, v65
    v_lshlrev_b32 v64, 16, v186
    v_and_b32 v65, 0xffff0000, v186
    v_fmac_f32 v14, v63, v64
    v_fmac_f32 v15, v63, v65
    v_lshlrev_b32 v64, 16, v187
    v_and_b32 v65, 0xffff0000, v187
    v_fmac_f32 v16, v63, v64
    v_fmac_f32 v17, v63, v65
    v_lshlrev_b32 v64, 16, v188
    v_and_b32 v65, 0xffff0000, v188
    v_fmac_f32 v18, v63, v64
    v_fmac_f32 v19, v63, v65
    v_lshlrev_b32 v64, 16, v189
    v_and_b32 v65, 0xffff0000, v189
    v_fmac_f32 v20, v63, v64
    v_fmac_f32 v21, v63, v65
    v_lshlrev_b32 v64, 16, v190
    v_and_b32 v65, 0xffff0000, v190
    v_fmac_f32 v22, v63, v64
    v_fmac_f32 v23, v63, v65
    v_lshlrev_b32 v64, 16, v191
    v_and_b32 v65, 0xffff0000, v191
    v_fmac_f32 v24, v63, v64
    v_fmac_f32 v25, v63, v65
    v_lshlrev_b32 v64, 16, v192
    v_and_b32 v65, 0xffff0000, v192
    v_fmac_f32 v26, v63, v64
    v_fmac_f32 v27, v63, v65
    v_lshlrev_b32 v64, 16, v193
    v_and_b32 v65, 0xffff0000, v193
    v_fmac_f32 v28, v63, v64
    v_fmac_f32 v29, v63, v65
    v_lshlrev_b32 v64, 16, v194
    v_and_b32 v65, 0xffff0000, v194
    v_fmac_f32 v30, v63, v64
    v_fmac_f32 v31, v63, v65
    v_lshlrev_b32 v64, 16, v195
    v_and_b32 v65, 0xffff0000, v195
    v_fmac_f32 v32, v63, v64
    v_fmac_f32 v33, v63, v65
    s_mov_b32 s10, 15360
    buffer_load_dwordx4 v[184:187], v5, s[52:55], s10 offen offset:0 nt
    buffer_load_dwordx4 v[188:191], v5, s[52:55], s10 offen offset:128 nt
    buffer_load_dwordx4 v[192:195], v5, s[52:55], s10 offen offset:256 nt
    v_mul_u32_u24 v66, 768, v7
    v_lshl_add_u32 v66, v3, 5, v66
    ds_write_b128 v66, v[10:13] offset:0
    ds_write_b128 v66, v[14:17] offset:16
    ds_write_b128 v66, v[18:21] offset:256
    ds_write_b128 v66, v[22:25] offset:272
    ds_write_b128 v66, v[26:29] offset:512
    ds_write_b128 v66, v[30:33] offset:528
    s_cmp_lg_u32 s3, 0
    s_cbranch_scc1 K1_NON2
    s_waitcnt vmcnt(30)
    v_readfirstlane_b32 s99, v76
    s_cmp_eq_u32 s99, 0
    s_cselect_b32 s99, s98, s99
    v_mov_b32 v76, s99
    v_mov_b32 v77, 0
    ds_write_b32 v77, v76 offset:50304
K1_NON2:
    s_waitcnt lgkmcnt(0)
    s_barrier
    v_mov_b32 v77, 0
    ds_read_b32 v76, v77 offset:50304
    s_waitcnt lgkmcnt(0)
    v_readfirstlane_b32 s99, v76
    s_cmp_ge_u32 s3, 3
    s_cbranch_scc1 K1_SKIPQ
    ds_read_b32 v10, v9 offset:0
    ds_read_b32 v11, v9 offset:768
    ds_read_b32 v12, v9 offset:1536
    ds_read_b32 v13, v9 offset:2304
    ds_read_b32 v14, v9 offset:3072
    ds_read_b32 v15, v9 offset:3840
    ds_read_b32 v16, v9 offset:4608
    ds_read_b32 v17, v9 offset:5376
    ds_read_b32 v18, v9 offset:6144
    ds_read_b32 v19, v9 offset:6912
    ds_read_b32 v20, v9 offset:7680
    ds_read_b32 v21, v9 offset:8448
    ds_read_b32 v22, v9 offset:9216
    ds_read_b32 v23, v9 offset:9984
    ds_read_b32 v24, v9 offset:10752
    ds_read_b32 v25, v9 offset:11520
    ds_read_b32 v26, v9 offset:12288
    ds_read_b32 v27, v9 offset:13056
    ds_read_b32 v28, v9 offset:13824
    ds_read_b32 v29, v9 offset:14592
    ds_read_b32 v30, v9 offset:15360
    ds_read_b32 v31, v9 offset:16128
    ds_read_b32 v32, v9 offset:16896
    ds_read_b32 v33, v9 offset:17664
    ds_read_b32 v46, v9 offset:18432
    ds_read_b32 v47, v9 offset:19200
    ds_read_b32 v48, v9 offset:19968
    ds_read_b32 v49, v9 offset:20736
    ds_read_b32 v50, v9 offset:21504
    ds_read_b32 v51, v9 offset:22272
    ds_read_b32 v52, v9 offset:23040
    ds_read_b32 v53, v9 offset:23808
    s_waitcnt lgkmcnt(15)
    v_mov_b32 v64, v10
    s_waitcnt lgkmcnt(15)
    v_add_f32 v64, v64, v11
    s_waitcnt lgkmcnt(15)
    v_add_f32 v64, v64, v12
    s_waitcnt lgkmcnt(15)
    v_add_f32 v64, v64, v13
    s_waitcnt lgkmcnt(15)
    v_add_f32 v64, v64, v14
    s_waitcnt lgkmcnt(15)
    v_add_f32 v64, v64, v15
    s_waitcnt lgkmcnt(15)
    v_add_f32 v64, v64, v16
    s_waitcnt lgkmcnt(15)
    v_add_f32 v64, v64, v17
    s_waitcnt lgkmcnt(15)
    v_add_f32 v64, v64, v18
    s_waitcnt lgkmcnt(15)
    v_add_f32 v64, v64, v19
    s_waitcnt lgkmcnt(15)
    v_add_f32 v64, v64, v20
    s_waitcnt lgkmcnt(15)
    v_add_f32 v64, v64, v21
    s_waitcnt lgkmcnt(15)
    v_add_f32 v64, v64, v22
    s_waitcnt lgkmcnt(15)
    v_add_f32 v64, v64, v23
    s_waitcnt lgkmcnt(15)
    v_add_f32 v64, v64, v24
    s_waitcnt lgkmcnt(15)
    v_add_f32 v64, v64, v25
    s_waitcnt lgkmcnt(15)
    v_add_f32 v64, v64, v26
    s_waitcnt lgkmcnt(14)
    v_add_f32 v64, v64, v27
    s_waitcnt lgkmcnt(13)
    v_add_f32 v64, v64, v28
    s_waitcnt lgkmcnt(12)
    v_add_f32 v64, v64, v29
    s_waitcnt lgkmcnt(11)
    v_add_f32 v64, v64, v30
    s_waitcnt lgkmcnt(10)
    v_add_f32 v64, v64, v31
    s_waitcnt lgkmcnt(9)
    v_add_f32 v64, v64, v32
    s_waitcnt lgkmcnt(8)
    v_add_f32 v64, v64, v33
    s_waitcnt lgkmcnt(7)
    v_add_f32 v64, v64, v46
    s_waitcnt lgkmcnt(6)
    v_add_f32 v64, v64, v47
    s_waitcnt lgkmcnt(5)
    v_add_f32 v64, v64, v48
    s_waitcnt lgkmcnt(4)
    v_add_f32 v64, v64, v49
    s_waitcnt lgkmcnt(3)
    v_add_f32 v64, v64, v50
    s_waitcnt lgkmcnt(2)
    v_add_f32 v64, v64, v51
    s_waitcnt lgkmcnt(1)
    v_add_f32 v64, v64, v52
    s_waitcnt lgkmcnt(0)
    v_add_f32 v64, v64, v53
    ds_read_b32 v10, v9 offset:24576
    ds_read_b32 v11, v9 offset:25344
    ds_read_b32 v12, v9 offset:26112
    ds_read_b32 v13, v9 offset:26880
    ds_read_b32 v14, v9 offset:27648
    ds_read_b32 v15, v9 offset:28416
    ds_read_b32 v16, v9 offset:29184
    ds_read_b32 v17, v9 offset:29952
    ds_read_b32 v18, v9 offset:30720
    ds_read_b32 v19, v9 offset:31488
    ds_read_b32 v20, v9 offset:32256
    ds_read_b32 v21, v9 offset:33024
    ds_read_b32 v22, v9 offset:33792
    ds_read_b32 v23, v9 offset:34560
    ds_read_b32 v24, v9 offset:35328
    ds_read_b32 v25, v9 offset:36096
    ds_read_b32 v26, v9 offset:36864
    ds_read_b32 v27, v9 offset:37632
    ds_read_b32 v28, v9 offset:38400
    ds_read_b32 v29, v9 offset:39168
    ds_read_b32 v30, v9 offset:39936
    ds_read_b32 v31, v9 offset:40704
    ds_read_b32 v32, v9 offset:41472
    ds_read_b32 v33, v9 offset:42240
    ds_read_b32 v46, v9 offset:43008
    ds_read_b32 v47, v9 offset:43776
    ds_read_b32 v48, v9 offset:44544
    ds_read_b32 v49, v9 offset:45312
    ds_read_b32 v50, v9 offset:46080
    ds_read_b32 v51, v9 offset:46848
    ds_read_b32 v52, v9 offset:47616
    ds_read_b32 v53, v9 offset:48384
    s_waitcnt lgkmcnt(15)
    v_add_f32 v64, v64, v10
    s_waitcnt lgkmcnt(15)
    v_add_f32 v64, v64, v11
    s_waitcnt lgkmcnt(15)
    v_add_f32 v64, v64, v12
    s_waitcnt lgkmcnt(15)
    v_add_f32 v64, v64, v13
    s_waitcnt lgkmcnt(15)
    v_add_f32 v64, v64, v14
    s_waitcnt lgkmcnt(15)
    v_add_f32 v64, v64, v15
    s_waitcnt lgkmcnt(15)
    v_add_f32 v64, v64, v16
    s_waitcnt lgkmcnt(15)
    v_add_f32 v64, v64, v17
    s_waitcnt lgkmcnt(15)
    v_add_f32 v64, v64, v18
    s_waitcnt lgkmcnt(15)
    v_add_f32 v64, v64, v19
    s_waitcnt lgkmcnt(15)
    v_add_f32 v64, v64, v20
    s_waitcnt lgkmcnt(15)
    v_add_f32 v64, v64, v21
    s_waitcnt lgkmcnt(15)
    v_add_f32 v64, v64, v22
    s_waitcnt lgkmcnt(15)
    v_add_f32 v64, v64, v23
    s_waitcnt lgkmcnt(15)
    v_add_f32 v64, v64, v24
    s_waitcnt lgkmcnt(15)
    v_add_f32 v64, v64, v25
    s_waitcnt lgkmcnt(15)
    v_add_f32 v64, v64, v26
    s_waitcnt lgkmcnt(14)
    v_add_f32 v64, v64, v27
    s_waitcnt lgkmcnt(13)
    v_add_f32 v64, v64, v28
    s_waitcnt lgkmcnt(12)
    v_add_f32 v64, v64, v29
    s_waitcnt lgkmcnt(11)
    v_add_f32 v64, v64, v30
    s_waitcnt lgkmcnt(10)
    v_add_f32 v64, v64, v31
    s_waitcnt lgkmcnt(9)
    v_add_f32 v64, v64, v32
    s_waitcnt lgkmcnt(8)
    v_add_f32 v64, v64, v33
    s_waitcnt lgkmcnt(7)
    v_add_f32 v64, v64, v46
    s_waitcnt lgkmcnt(6)
    v_add_f32 v64, v64, v47
    s_waitcnt lgkmcnt(5)
    v_add_f32 v64, v64, v48
    s_waitcnt lgkmcnt(4)
    v_add_f32 v64, v64, v49
    s_waitcnt lgkmcnt(3)
    v_add_f32 v64, v64, v50
    s_waitcnt lgkmcnt(2)
    v_add_f32 v64, v64, v51
    s_waitcnt lgkmcnt(1)
    v_add_f32 v64, v64, v52
    s_waitcnt lgkmcnt(0)
    v_add_f32 v64, v64, v53
    v_cvt_pk_bf16_f32 v64, v64, v64
    v_lshlrev_b32 v65, 1, v0
    ds_write_b16 v65, v64 offset:49152
    s_branch K1_SKIPB
K1_SKIPQ:
    s_cmp_lg_u32 s3, 3
    s_cbranch_scc1 K1_SKIPB
    ds_read_b32 v10, v8 offset:50048
    ds_read_b32 v11, v8 offset:50060
    ds_read_b32 v12, v8 offset:50072
    ds_read_b32 v13, v8 offset:50084
    s_waitcnt lgkmcnt(0)
    v_add_f32 v10, v10, v11
    v_add_f32 v10, v10, v12
    v_add_f32 v10, v10, v13
    v_cvt_pk_bf16_f32 v10, v10, v10
    v_lshlrev_b32 v10, 16, v10
    v_lshlrev_b32 v74, 16, v74
    v_add_f32 v10, v10, v74
    v_cvt_pk_bf16_f32 v10, v10, v10
    v_lshlrev_b32 v10, 16, v10
    v_mul_f32 v11, 0xbfb8aa3b, v10
    v_exp_f32 v11, v11
    s_nop 0
    v_add_f32 v11, 1.0, v11
    v_rcp_f32 v11, v11
    s_nop 0
    v_mul_f32 v10, v10, v11
    v_cvt_pk_bf16_f32 v10, v10, v10
    v_lshlrev_b32 v10, 16, v10
    s_cmp_lt_u32 s2, 128
    s_cselect_b32 s8, 7, 3
    s_mov_b32 s9, 0
    s_mov_b64 s[14:15], exec
    s_mov_b64 exec, s[8:9]
    v_lshlrev_b32 v12, 11, v1
    s_lshl_b32 s8, s2, 3
    s_add_u32 s8, s8, 524288
    v_add_u32 v12, s8, v12
    v_mov_b32 v11, s99
    buffer_store_dwordx2 v[10:11], v12, s[76:79], 0 offen sc1
    s_mov_b64 exec, s[14:15]
K1_SKIPB:
    s_waitcnt lgkmcnt(0)
    s_barrier
    v_lshlrev_b32 v64, 4, v3
    ds_read_b128 v[34:37], v64 offset:49152
    ds_read_b128 v[38:41], v64 offset:49280
    ds_read_b128 v[42:45], v64 offset:49408
    s_waitcnt lgkmcnt(0)
    v_dot2_f32_bf16 v64, v100, v34, 0
    v_dot2_f32_bf16 v64, v101, v35, v64
    v_dot2_f32_bf16 v64, v102, v36, v64
    v_dot2_f32_bf16 v64, v103, v37, v64
    v_dot2_f32_bf16 v64, v104, v38, v64
    v_dot2_f32_bf16 v64, v105, v39, v64
    v_dot2_f32_bf16 v64, v106, v40, v64
    v_dot2_f32_bf16 v64, v107, v41, v64
    v_dot2_f32_bf16 v64, v108, v42, v64
    v_dot2_f32_bf16 v64, v109, v43, v64
    v_dot2_f32_bf16 v64, v110, v44, v64
    v_dot2_f32_bf16 v64, v111, v45, v64
    s_mov_b32 s10, 18432
    buffer_load_dwordx4 v[100:103], v5, s[52:55], s10 offen offset:0 nt
    buffer_load_dwordx4 v[104:107], v5, s[52:55], s10 offen offset:128 nt
    buffer_load_dwordx4 v[108:111], v5, s[52:55], s10 offen offset:256 nt
    v_add_f32_dpp v64, v64, v64 quad_perm:[1,0,3,2] row_mask:0xf bank_mask:0xf
    s_nop 1
    v_add_f32_dpp v64, v64, v64 quad_perm:[2,3,0,1] row_mask:0xf bank_mask:0xf
    s_nop 1
    v_add_f32_dpp v64, v64, v64 row_half_mirror row_mask:0xf bank_mask:0xf
    v_cvt_pk_bf16_f32 v64, v64, v64
    v_lshlrev_b32 v64, 16, v64
    v_mul_f32 v64, 0x3d93cd3a, v64
    v_cvt_pk_bf16_f32 v46, v64, v64
    v_lshlrev_b32 v46, 16, v46
    v_dot2_f32_bf16 v64, v124, v34, 0
    v_dot2_f32_bf16 v64, v125, v35, v64
    v_dot2_f32_bf16 v64, v126, v36, v64
    v_dot2_f32_bf16 v64, v127, v37, v64
    v_dot2_f32_bf16 v64, v128, v38, v64
    v_dot2_f32_bf16 v64, v129, v39, v64
    v_dot2_f32_bf16 v64, v130, v40, v64
    v_dot2_f32_bf16 v64, v131, v41, v64
    v_dot2_f32_bf16 v64, v132, v42, v64
    v_dot2_f32_bf16 v64, v133, v43, v64
    v_dot2_f32_bf16 v64, v134, v44, v64
    v_dot2_f32_bf16 v64, v135, v45, v64
    s_mov_b32 s10, 21504
    buffer_load_dwordx4 v[124:127], v5, s[52:55], s10 offen offset:0 nt
    buffer_load_dwordx4 v[128:131], v5, s[52:55], s10 offen offset:128 nt
    buffer_load_dwordx4 v[132:135], v5, s[52:55], s10 offen offset:256 nt
    v_add_f32_dpp v64, v64, v64 quad_perm:[1,0,3,2] row_mask:0xf bank_mask:0xf
    s_nop 1
    v_add_f32_dpp v64, v64, v64 quad_perm:[2,3,0,1] row_mask:0xf bank_mask:0xf
    s_nop 1
    v_add_f32_dpp v64, v64, v64 row_half_mirror row_mask:0xf bank_mask:0xf
    v_cvt_pk_bf16_f32 v64, v64, v64
    v_lshlrev_b32 v64, 16, v64
    v_mul_f32 v64, 0x3d93cd3a, v64
    v_cvt_pk_bf16_f32 v47, v64, v64
    v_lshlrev_b32 v47, 16, v47
    v_dot2_f32_bf16 v64, v148, v34, 0
    v_dot2_f32_bf16 v64, v149, v35, v64
    v_dot2_f32_bf16 v64, v150, v36, v64
    v_dot2_f32_bf16 v64, v151, v37, v64
    v_dot2_f32_bf16 v64, v152, v38, v64
    v_dot2_f32_bf16 v64, v153, v39, v64
    v_dot2_f32_bf16 v64, v154, v40, v64
    v_dot2_f32_bf16 v64, v155, v41, v64
    v_dot2_f32_bf16 v64, v156, v42, v64
    v_dot2_f32_bf16 v64, v157, v43, v64
    v_dot2_f32_bf16 v64, v158, v44, v64
    v_dot2_f32_bf16 v64, v159, v45, v64
    s_mov_b32 s10, 0
    buffer_load_dwordx4 v[148:151], v75, s[84:87], s10 offen nt
    s_mov_b32 s10, 61440
    buffer_load_dwordx4 v[152:155], v75, s[84:87], s10 offen nt
    s_mov_b32 s10, 122880
    buffer_load_dwordx4 v[156:159], v75, s[84:87], s10 offen nt
    v_add_f32_dpp v64, v64, v64 quad_perm:[1,0,3,2] row_mask:0xf bank_mask:0xf
    s_nop 1
    v_add_f32_dpp v64, v64, v64 quad_perm:[2,3,0,1] row_mask:0xf bank_mask:0xf
    s_nop 1
    v_add_f32_dpp v64, v64, v64 row_half_mirror row_mask:0xf bank_mask:0xf
    v_cvt_pk_bf16_f32 v64, v64, v64
    v_lshlrev_b32 v64, 16, v64
    v_mul_f32 v64, 0x3d93cd3a, v64
    v_cvt_pk_bf16_f32 v48, v64, v64
    v_lshlrev_b32 v48, 16, v48
    v_dot2_f32_bf16 v64, v172, v34, 0
    v_dot2_f32_bf16 v64, v173, v35, v64
    v_dot2_f32_bf16 v64, v174, v36, v64
    v_dot2_f32_bf16 v64, v175, v37, v64
    v_dot2_f32_bf16 v64, v176, v38, v64
    v_dot2_f32_bf16 v64, v177, v39, v64
    v_dot2_f32_bf16 v64, v178, v40, v64
    v_dot2_f32_bf16 v64, v179, v41, v64
    v_dot2_f32_bf16 v64, v180, v42, v64
    v_dot2_f32_bf16 v64, v181, v43, v64
    v_dot2_f32_bf16 v64, v182, v44, v64
    v_dot2_f32_bf16 v64, v183, v45, v64
    s_mov_b32 s10, 184320
    buffer_load_dwordx4 v[172:175], v75, s[84:87], s10 offen nt
    v_add_f32_dpp v64, v64, v64 quad_perm:[1,0,3,2] row_mask:0xf bank_mask:0xf
    s_nop 1
    v_add_f32_dpp v64, v64, v64 quad_perm:[2,3,0,1] row_mask:0xf bank_mask:0xf
    s_nop 1
    v_add_f32_dpp v64, v64, v64 row_half_mirror row_mask:0xf bank_mask:0xf
    v_cvt_pk_bf16_f32 v64, v64, v64
    v_lshlrev_b32 v64, 16, v64
    v_mul_f32 v64, 0x3d93cd3a, v64
    v_cvt_pk_bf16_f32 v49, v64, v64
    v_lshlrev_b32 v49, 16, v49
    v_dot2_f32_bf16 v64, v196, v34, 0
    v_dot2_f32_bf16 v64, v197, v35, v64
    v_dot2_f32_bf16 v64, v198, v36, v64
    v_dot2_f32_bf16 v64, v199, v37, v64
    v_dot2_f32_bf16 v64, v200, v38, v64
    v_dot2_f32_bf16 v64, v201, v39, v64
    v_dot2_f32_bf16 v64, v202, v40, v64
    v_dot2_f32_bf16 v64, v203, v41, v64
    v_dot2_f32_bf16 v64, v204, v42, v64
    v_dot2_f32_bf16 v64, v205, v43, v64
    v_dot2_f32_bf16 v64, v206, v44, v64
    v_dot2_f32_bf16 v64, v207, v45, v64
    s_nop 2
    v_add_f32_dpp v64, v64, v64 quad_perm:[1,0,3,2] row_mask:0xf bank_mask:0xf
    s_nop 1
    v_add_f32_dpp v64, v64, v64 quad_perm:[2,3,0,1] row_mask:0xf bank_mask:0xf
    s_nop 1
    v_add_f32_dpp v64, v64, v64 row_half_mirror row_mask:0xf bank_mask:0xf
    v_cvt_pk_bf16_f32 v64, v64, v64
    v_lshlrev_b32 v64, 16, v64
    v_mul_f32 v64, 0x3d93cd3a, v64
    v_cvt_pk_bf16_f32 v50, v64, v64
    v_lshlrev_b32 v50, 16, v50
    v_dot2_f32_bf16 v64, v220, v34, 0
    v_dot2_f32_bf16 v64, v221, v35, v64
    v_dot2_f32_bf16 v64, v222, v36, v64
    v_dot2_f32_bf16 v64, v223, v37, v64
    v_dot2_f32_bf16 v64, v224, v38, v64
    v_dot2_f32_bf16 v64, v225, v39, v64
    v_dot2_f32_bf16 v64, v226, v40, v64
    v_dot2_f32_bf16 v64, v227, v41, v64
    v_dot2_f32_bf16 v64, v228, v42, v64
    v_dot2_f32_bf16 v64, v229, v43, v64
    v_dot2_f32_bf16 v64, v230, v44, v64
    v_dot2_f32_bf16 v64, v231, v45, v64
    s_nop 2
    v_add_f32_dpp v64, v64, v64 quad_perm:[1,0,3,2] row_mask:0xf bank_mask:0xf
    s_nop 1
    v_add_f32_dpp v64, v64, v64 quad_perm:[2,3,0,1] row_mask:0xf bank_mask:0xf
    s_nop 1
    v_add_f32_dpp v64, v64, v64 row_half_mirror row_mask:0xf bank_mask:0xf
    v_cvt_pk_bf16_f32 v64, v64, v64
    v_lshlrev_b32 v64, 16, v64
    v_mul_f32 v64, 0x3d93cd3a, v64
    v_cvt_pk_bf16_f32 v51, v64, v64
    v_lshlrev_b32 v51, 16, v51
    v_dot2_f32_bf16 v64, v244, v34, 0
    v_dot2_f32_bf16 v64, v245, v35, v64
    v_dot2_f32_bf16 v64, v246, v36, v64
    v_dot2_f32_bf16 v64, v247, v37, v64
    v_dot2_f32_bf16 v64, v248, v38, v64
    v_dot2_f32_bf16 v64, v249, v39, v64
    v_dot2_f32_bf16 v64, v250, v40, v64
    v_dot2_f32_bf16 v64, v251, v41, v64
    v_dot2_f32_bf16 v64, v252, v42, v64
    v_dot2_f32_bf16 v64, v253, v43, v64
    v_dot2_f32_bf16 v64, v254, v44, v64
    v_dot2_f32_bf16 v64, v255, v45, v64
    s_nop 2
    v_add_f32_dpp v64, v64, v64 quad_perm:[1,0,3,2] row_mask:0xf bank_mask:0xf
    s_nop 1
    v_add_f32_dpp v64, v64, v64 quad_perm:[2,3,0,1] row_mask:0xf bank_mask:0xf
    s_nop 1
    v_add_f32_dpp v64, v64, v64 row_half_mirror row_mask:0xf bank_mask:0xf
    v_cvt_pk_bf16_f32 v64, v64, v64
    v_lshlrev_b32 v64, 16, v64
    v_mul_f32 v64, 0x3d93cd3a, v64
    v_cvt_pk_bf16_f32 v52, v64, v64
    v_lshlrev_b32 v52, 16, v52
    v_dot2_f32_bf16 v64, v112, v34, 0
    v_dot2_f32_bf16 v64, v113, v35, v64
    v_dot2_f32_bf16 v64, v114, v36, v64
    v_dot2_f32_bf16 v64, v115, v37, v64
    v_dot2_f32_bf16 v64, v116, v38, v64
    v_dot2_f32_bf16 v64, v117, v39, v64
    v_dot2_f32_bf16 v64, v118, v40, v64
    v_dot2_f32_bf16 v64, v119, v41, v64
    v_dot2_f32_bf16 v64, v120, v42, v64
    v_dot2_f32_bf16 v64, v121, v43, v64
    v_dot2_f32_bf16 v64, v122, v44, v64
    v_dot2_f32_bf16 v64, v123, v45, v64
    s_nop 2
    v_add_f32_dpp v64, v64, v64 quad_perm:[1,0,3,2] row_mask:0xf bank_mask:0xf
    s_nop 1
    v_add_f32_dpp v64, v64, v64 quad_perm:[2,3,0,1] row_mask:0xf bank_mask:0xf
    s_nop 1
    v_add_f32_dpp v64, v64, v64 row_half_mirror row_mask:0xf bank_mask:0xf
    v_cvt_pk_bf16_f32 v64, v64, v64
    v_lshlrev_b32 v64, 16, v64
    v_mul_f32 v64, 0x3d93cd3a, v64
    v_cvt_pk_bf16_f32 v53, v64, v64
    v_lshlrev_b32 v53, 16, v53
    v_max_f32 v68, v46, v47
    v_max_f32 v68, v68, v48
    v_max_f32 v68, v68, v49
    v_max_f32 v68, v68, v50
    v_max_f32 v68, v68, v51
    v_max_f32 v68, v68, v52
    v_max_f32 v68, v68, v53
    v_sub_f32 v46, v46, v68
    v_mul_f32 v46, 0x3fb8aa3b, v46
    v_exp_f32 v46, v46
    v_sub_f32 v47, v47, v68
    v_mul_f32 v47, 0x3fb8aa3b, v47
    v_exp_f32 v47, v47
    v_sub_f32 v48, v48, v68
    v_mul_f32 v48, 0x3fb8aa3b, v48
    v_exp_f32 v48, v48
    v_sub_f32 v49, v49, v68
    v_mul_f32 v49, 0x3fb8aa3b, v49
    v_exp_f32 v49, v49
    v_sub_f32 v50, v50, v68
    v_mul_f32 v50, 0x3fb8aa3b, v50
    v_exp_f32 v50, v50
    v_sub_f32 v51, v51, v68
    v_mul_f32 v51, 0x3fb8aa3b, v51
    v_exp_f32 v51, v51
    v_sub_f32 v52, v52, v68
    v_mul_f32 v52, 0x3fb8aa3b, v52
    v_exp_f32 v52, v52
    v_sub_f32 v53, v53, v68
    v_mul_f32 v53, 0x3fb8aa3b, v53
    v_exp_f32 v53, v53
    s_nop 0
    v_add_f32 v69, v46, v47
    v_add_f32 v69, v69, v48
    v_add_f32 v69, v69, v49
    v_add_f32 v69, v69, v50
    v_add_f32 v69, v69, v51
    v_add_f32 v69, v69, v52
    v_add_f32 v69, v69, v53
    v_mov_b32 v10, 0
    v_mov_b32 v11, 0
    v_mov_b32 v12, 0
    v_mov_b32 v13, 0
    v_mov_b32 v14, 0
    v_mov_b32 v15, 0
    v_mov_b32 v16, 0
    v_mov_b32 v17, 0
    v_mov_b32 v18, 0
    v_mov_b32 v19, 0
    v_mov_b32 v20, 0
    v_mov_b32 v21, 0
    v_mov_b32 v22, 0
    v_mov_b32 v23, 0
    v_mov_b32 v24, 0
    v_mov_b32 v25, 0
    v_mov_b32 v26, 0
    v_mov_b32 v27, 0
    v_mov_b32 v28, 0
    v_mov_b32 v29, 0
    v_mov_b32 v30, 0
    v_mov_b32 v31, 0
    v_mov_b32 v32, 0
    v_mov_b32 v33, 0
    v_lshlrev_b32 v64, 16, v160
    v_and_b32 v65, 0xffff0000, v160
    v_fmac_f32 v10, v46, v64
    v_fmac_f32 v11, v46, v65
    v_lshlrev_b32 v64, 16, v161
    v_and_b32 v65, 0xffff0000, v161
    v_fmac_f32 v12, v46, v64
    v_fmac_f32 v13, v46, v65
    v_lshlrev_b32 v64, 16, v162
    v_and_b32 v65, 0xffff0000, v162
    v_fmac_f32 v14, v46, v64
    v_fmac_f32 v15, v46, v65
    v_lshlrev_b32 v64, 16, v163
    v_and_b32 v65, 0xffff0000, v163
    v_fmac_f32 v16, v46, v64
    v_fmac_f32 v17, v46, v65
    v_lshlrev_b32 v64, 16, v164
    v_and_b32 v65, 0xffff0000, v164
    v_fmac_f32 v18, v46, v64
    v_fmac_f32 v19, v46, v65
    v_lshlrev_b32 v64, 16, v165
    v_and_b32 v65, 0xffff0000, v165
    v_fmac_f32 v20, v46, v64
    v_fmac_f32 v21, v46, v65
    v_lshlrev_b32 v64, 16, v166
    v_and_b32 v65, 0xffff0000, v166
    v_fmac_f32 v22, v46, v64
    v_fmac_f32 v23, v46, v65
    v_lshlrev_b32 v64, 16, v167
    v_and_b32 v65, 0xffff0000, v167
    v_fmac_f32 v24, v46, v64
    v_fmac_f32 v25, v46, v65
    v_lshlrev_b32 v64, 16, v168
    v_and_b32 v65, 0xffff0000, v168
    v_fmac_f32 v26, v46, v64
    v_fmac_f32 v27, v46, v65
    v_lshlrev_b32 v64, 16, v169
    v_and_b32 v65, 0xffff0000, v169
    v_fmac_f32 v28, v46, v64
    v_fmac_f32 v29, v46, v65
    v_lshlrev_b32 v64, 16, v170
    v_and_b32 v65, 0xffff0000, v170
    v_fmac_f32 v30, v46, v64
    v_fmac_f32 v31, v46, v65
    v_lshlrev_b32 v64, 16, v171
    v_and_b32 v65, 0xffff0000, v171
    v_fmac_f32 v32, v46, v64
    v_fmac_f32 v33, v46, v65
    s_waitcnt vmcnt(22)
    v_lshlrev_b32 v64, 16, v208
    v_and_b32 v65, 0xffff0000, v208
    v_fmac_f32 v10, v47, v64
    v_fmac_f32 v11, v47, v65
    v_lshlrev_b32 v64, 16, v209
    v_and_b32 v65, 0xffff0000, v209
    v_fmac_f32 v12, v47, v64
    v_fmac_f32 v13, v47, v65
    v_lshlrev_b32 v64, 16, v210
    v_and_b32 v65, 0xffff0000, v210
    v_fmac_f32 v14, v47, v64
    v_fmac_f32 v15, v47, v65
    v_lshlrev_b32 v64, 16, v211
    v_and_b32 v65, 0xffff0000, v211
    v_fmac_f32 v16, v47, v64
    v_fmac_f32 v17, v47, v65
    v_lshlrev_b32 v64, 16, v212
    v_and_b32 v65, 0xffff0000, v212
    v_fmac_f32 v18, v47, v64
    v_fmac_f32 v19, v47, v65
    v_lshlrev_b32 v64, 16, v213
    v_and_b32 v65, 0xffff0000, v213
    v_fmac_f32 v20, v47, v64
    v_fmac_f32 v21, v47, v65
    v_lshlrev_b32 v64, 16, v214
    v_and_b32 v65, 0xffff0000, v214
    v_fmac_f32 v22, v47, v64
    v_fmac_f32 v23, v47, v65
    v_lshlrev_b32 v64, 16, v215
    v_and_b32 v65, 0xffff0000, v215
    v_fmac_f32 v24, v47, v64
    v_fmac_f32 v25, v47, v65
    v_lshlrev_b32 v64, 16, v216
    v_and_b32 v65, 0xffff0000, v216
    v_fmac_f32 v26, v47, v64
    v_fmac_f32 v27, v47, v65
    v_lshlrev_b32 v64, 16, v217
    v_and_b32 v65, 0xffff0000, v217
    v_fmac_f32 v28, v47, v64
    v_fmac_f32 v29, v47, v65
    v_lshlrev_b32 v64, 16, v218
    v_and_b32 v65, 0xffff0000, v218
    v_fmac_f32 v30, v47, v64
    v_fmac_f32 v31, v47, v65
    v_lshlrev_b32 v64, 16, v219
    v_and_b32 v65, 0xffff0000, v219
    v_fmac_f32 v32, v47, v64
    v_fmac_f32 v33, v47, v65
    s_waitcnt vmcnt(19)
    v_lshlrev_b32 v64, 16, v232
    v_and_b32 v65, 0xffff0000, v232
    v_fmac_f32 v10, v48, v64
    v_fmac_f32 v11, v48, v65
    v_lshlrev_b32 v64, 16, v233
    v_and_b32 v65, 0xffff0000, v233
    v_fmac_f32 v12, v48, v64
    v_fmac_f32 v13, v48, v65
    v_lshlrev_b32 v64, 16, v234
    v_and_b32 v65, 0xffff0000, v234
    v_fmac_f32 v14, v48, v64
    v_fmac_f32 v15, v48, v65
    v_lshlrev_b32 v64, 16, v235
    v_and_b32 v65, 0xffff0000, v235
    v_fmac_f32 v16, v48, v64
    v_fmac_f32 v17, v48, v65
    v_lshlrev_b32 v64, 16, v236
    v_and_b32 v65, 0xffff0000, v236
    v_fmac_f32 v18, v48, v64
    v_fmac_f32 v19, v48, v65
    v_lshlrev_b32 v64, 16, v237
    v_and_b32 v65, 0xffff0000, v237
    v_fmac_f32 v20, v48, v64
    v_fmac_f32 v21, v48, v65
    v_lshlrev_b32 v64, 16, v238
    v_and_b32 v65, 0xffff0000, v238
    v_fmac_f32 v22, v48, v64
    v_fmac_f32 v23, v48, v65
    v_lshlrev_b32 v64, 16, v239
    v_and_b32 v65, 0xffff0000, v239
    v_fmac_f32 v24, v48, v64
    v_fmac_f32 v25, v48, v65
    v_lshlrev_b32 v64, 16, v240
    v_and_b32 v65, 0xffff0000, v240
    v_fmac_f32 v26, v48, v64
    v_fmac_f32 v27, v48, v65
    v_lshlrev_b32 v64, 16, v241
    v_and_b32 v65, 0xffff0000, v241
    v_fmac_f32 v28, v48, v64
    v_fmac_f32 v29, v48, v65
    v_lshlrev_b32 v64, 16, v242
    v_and_b32 v65, 0xffff0000, v242
    v_fmac_f32 v30, v48, v64
    v_fmac_f32 v31, v48, v65
    v_lshlrev_b32 v64, 16, v243
    v_and_b32 v65, 0xffff0000, v243
    v_fmac_f32 v32, v48, v64
    v_fmac_f32 v33, v48, v65
    s_waitcnt vmcnt(16)
    v_lshlrev_b32 v64, 16, v88
    v_and_b32 v65, 0xffff0000, v88
    v_fmac_f32 v10, v49, v64
    v_fmac_f32 v11, v49, v65
    v_lshlrev_b32 v64, 16, v89
    v_and_b32 v65, 0xffff0000, v89
    v_fmac_f32 v12, v49, v64
    v_fmac_f32 v13, v49, v65
    v_lshlrev_b32 v64, 16, v90
    v_and_b32 v65, 0xffff0000, v90
    v_fmac_f32 v14, v49, v64
    v_fmac_f32 v15, v49, v65
    v_lshlrev_b32 v64, 16, v91
    v_and_b32 v65, 0xffff0000, v91
    v_fmac_f32 v16, v49, v64
    v_fmac_f32 v17, v49, v65
    v_lshlrev_b32 v64, 16, v92
    v_and_b32 v65, 0xffff0000, v92
    v_fmac_f32 v18, v49, v64
    v_fmac_f32 v19, v49, v65
    v_lshlrev_b32 v64, 16, v93
    v_and_b32 v65, 0xffff0000, v93
    v_fmac_f32 v20, v49, v64
    v_fmac_f32 v21, v49, v65
    v_lshlrev_b32 v64, 16, v94
    v_and_b32 v65, 0xffff0000, v94
    v_fmac_f32 v22, v49, v64
    v_fmac_f32 v23, v49, v65
    v_lshlrev_b32 v64, 16, v95
    v_and_b32 v65, 0xffff0000, v95
    v_fmac_f32 v24, v49, v64
    v_fmac_f32 v25, v49, v65
    v_lshlrev_b32 v64, 16, v96
    v_and_b32 v65, 0xffff0000, v96
    v_fmac_f32 v26, v49, v64
    v_fmac_f32 v27, v49, v65
    v_lshlrev_b32 v64, 16, v97
    v_and_b32 v65, 0xffff0000, v97
    v_fmac_f32 v28, v49, v64
    v_fmac_f32 v29, v49, v65
    v_lshlrev_b32 v64, 16, v98
    v_and_b32 v65, 0xffff0000, v98
    v_fmac_f32 v30, v49, v64
    v_fmac_f32 v31, v49, v65
    v_lshlrev_b32 v64, 16, v99
    v_and_b32 v65, 0xffff0000, v99
    v_fmac_f32 v32, v49, v64
    v_fmac_f32 v33, v49, v65
    s_waitcnt vmcnt(13)
    v_lshlrev_b32 v64, 16, v136
    v_and_b32 v65, 0xffff0000, v136
    v_fmac_f32 v10, v50, v64
    v_fmac_f32 v11, v50, v65
    v_lshlrev_b32 v64, 16, v137
    v_and_b32 v65, 0xffff0000, v137
    v_fmac_f32 v12, v50, v64
    v_fmac_f32 v13, v50, v65
    v_lshlrev_b32 v64, 16, v138
    v_and_b32 v65, 0xffff0000, v138
    v_fmac_f32 v14, v50, v64
    v_fmac_f32 v15, v50, v65
    v_lshlrev_b32 v64, 16, v139
    v_and_b32 v65, 0xffff0000, v139
    v_fmac_f32 v16, v50, v64
    v_fmac_f32 v17, v50, v65
    v_lshlrev_b32 v64, 16, v140
    v_and_b32 v65, 0xffff0000, v140
    v_fmac_f32 v18, v50, v64
    v_fmac_f32 v19, v50, v65
    v_lshlrev_b32 v64, 16, v141
    v_and_b32 v65, 0xffff0000, v141
    v_fmac_f32 v20, v50, v64
    v_fmac_f32 v21, v50, v65
    v_lshlrev_b32 v64, 16, v142
    v_and_b32 v65, 0xffff0000, v142
    v_fmac_f32 v22, v50, v64
    v_fmac_f32 v23, v50, v65
    v_lshlrev_b32 v64, 16, v143
    v_and_b32 v65, 0xffff0000, v143
    v_fmac_f32 v24, v50, v64
    v_fmac_f32 v25, v50, v65
    v_lshlrev_b32 v64, 16, v144
    v_and_b32 v65, 0xffff0000, v144
    v_fmac_f32 v26, v50, v64
    v_fmac_f32 v27, v50, v65
    v_lshlrev_b32 v64, 16, v145
    v_and_b32 v65, 0xffff0000, v145
    v_fmac_f32 v28, v50, v64
    v_fmac_f32 v29, v50, v65
    v_lshlrev_b32 v64, 16, v146
    v_and_b32 v65, 0xffff0000, v146
    v_fmac_f32 v30, v50, v64
    v_fmac_f32 v31, v50, v65
    v_lshlrev_b32 v64, 16, v147
    v_and_b32 v65, 0xffff0000, v147
    v_fmac_f32 v32, v50, v64
    v_fmac_f32 v33, v50, v65
    s_waitcnt vmcnt(10)
    v_lshlrev_b32 v64, 16, v184
    v_and_b32 v65, 0xffff0000, v184
    v_fmac_f32 v10, v51, v64
    v_fmac_f32 v11, v51, v65
    v_lshlrev_b32 v64, 16, v185
    v_and_b32 v65, 0xffff0000, v185
    v_fmac_f32 v12, v51, v64
    v_fmac_f32 v13, v51, v65
    v_lshlrev_b32 v64, 16, v186
    v_and_b32 v65, 0xffff0000, v186
    v_fmac_f32 v14, v51, v64
    v_fmac_f32 v15, v51, v65
    v_lshlrev_b32 v64, 16, v187
    v_and_b32 v65, 0xffff0000, v187
    v_fmac_f32 v16, v51, v64
    v_fmac_f32 v17, v51, v65
    v_lshlrev_b32 v64, 16, v188
    v_and_b32 v65, 0xffff0000, v188
    v_fmac_f32 v18, v51, v64
    v_fmac_f32 v19, v51, v65
    v_lshlrev_b32 v64, 16, v189
    v_and_b32 v65, 0xffff0000, v189
    v_fmac_f32 v20, v51, v64
    v_fmac_f32 v21, v51, v65
    v_lshlrev_b32 v64, 16, v190
    v_and_b32 v65, 0xffff0000, v190
    v_fmac_f32 v22, v51, v64
    v_fmac_f32 v23, v51, v65
    v_lshlrev_b32 v64, 16, v191
    v_and_b32 v65, 0xffff0000, v191
    v_fmac_f32 v24, v51, v64
    v_fmac_f32 v25, v51, v65
    v_lshlrev_b32 v64, 16, v192
    v_and_b32 v65, 0xffff0000, v192
    v_fmac_f32 v26, v51, v64
    v_fmac_f32 v27, v51, v65
    v_lshlrev_b32 v64, 16, v193
    v_and_b32 v65, 0xffff0000, v193
    v_fmac_f32 v28, v51, v64
    v_fmac_f32 v29, v51, v65
    v_lshlrev_b32 v64, 16, v194
    v_and_b32 v65, 0xffff0000, v194
    v_fmac_f32 v30, v51, v64
    v_fmac_f32 v31, v51, v65
    v_lshlrev_b32 v64, 16, v195
    v_and_b32 v65, 0xffff0000, v195
    v_fmac_f32 v32, v51, v64
    v_fmac_f32 v33, v51, v65
    s_waitcnt vmcnt(7)
    v_lshlrev_b32 v64, 16, v100
    v_and_b32 v65, 0xffff0000, v100
    v_fmac_f32 v10, v52, v64
    v_fmac_f32 v11, v52, v65
    v_lshlrev_b32 v64, 16, v101
    v_and_b32 v65, 0xffff0000, v101
    v_fmac_f32 v12, v52, v64
    v_fmac_f32 v13, v52, v65
    v_lshlrev_b32 v64, 16, v102
    v_and_b32 v65, 0xffff0000, v102
    v_fmac_f32 v14, v52, v64
    v_fmac_f32 v15, v52, v65
    v_lshlrev_b32 v64, 16, v103
    v_and_b32 v65, 0xffff0000, v103
    v_fmac_f32 v16, v52, v64
    v_fmac_f32 v17, v52, v65
    v_lshlrev_b32 v64, 16, v104
    v_and_b32 v65, 0xffff0000, v104
    v_fmac_f32 v18, v52, v64
    v_fmac_f32 v19, v52, v65
    v_lshlrev_b32 v64, 16, v105
    v_and_b32 v65, 0xffff0000, v105
    v_fmac_f32 v20, v52, v64
    v_fmac_f32 v21, v52, v65
    v_lshlrev_b32 v64, 16, v106
    v_and_b32 v65, 0xffff0000, v106
    v_fmac_f32 v22, v52, v64
    v_fmac_f32 v23, v52, v65
    v_lshlrev_b32 v64, 16, v107
    v_and_b32 v65, 0xffff0000, v107
    v_fmac_f32 v24, v52, v64
    v_fmac_f32 v25, v52, v65
    v_lshlrev_b32 v64, 16, v108
    v_and_b32 v65, 0xffff0000, v108
    v_fmac_f32 v26, v52, v64
    v_fmac_f32 v27, v52, v65
    v_lshlrev_b32 v64, 16, v109
    v_and_b32 v65, 0xffff0000, v109
    v_fmac_f32 v28, v52, v64
    v_fmac_f32 v29, v52, v65
    v_lshlrev_b32 v64, 16, v110
    v_and_b32 v65, 0xffff0000, v110
    v_fmac_f32 v30, v52, v64
    v_fmac_f32 v31, v52, v65
    v_lshlrev_b32 v64, 16, v111
    v_and_b32 v65, 0xffff0000, v111
    v_fmac_f32 v32, v52, v64
    v_fmac_f32 v33, v52, v65
    s_waitcnt vmcnt(4)
    v_lshlrev_b32 v64, 16, v124
    v_and_b32 v65, 0xffff0000, v124
    v_fmac_f32 v10, v53, v64
    v_fmac_f32 v11, v53, v65
    v_lshlrev_b32 v64, 16, v125
    v_and_b32 v65, 0xffff0000, v125
    v_fmac_f32 v12, v53, v64
    v_fmac_f32 v13, v53, v65
    v_lshlrev_b32 v64, 16, v126
    v_and_b32 v65, 0xffff0000, v126
    v_fmac_f32 v14, v53, v64
    v_fmac_f32 v15, v53, v65
    v_lshlrev_b32 v64, 16, v127
    v_and_b32 v65, 0xffff0000, v127
    v_fmac_f32 v16, v53, v64
    v_fmac_f32 v17, v53, v65
    v_lshlrev_b32 v64, 16, v128
    v_and_b32 v65, 0xffff0000, v128
    v_fmac_f32 v18, v53, v64
    v_fmac_f32 v19, v53, v65
    v_lshlrev_b32 v64, 16, v129
    v_and_b32 v65, 0xffff0000, v129
    v_fmac_f32 v20, v53, v64
    v_fmac_f32 v21, v53, v65
    v_lshlrev_b32 v64, 16, v130
    v_and_b32 v65, 0xffff0000, v130
    v_fmac_f32 v22, v53, v64
    v_fmac_f32 v23, v53, v65
    v_lshlrev_b32 v64, 16, v131
    v_and_b32 v65, 0xffff0000, v131
    v_fmac_f32 v24, v53, v64
    v_fmac_f32 v25, v53, v65
    v_lshlrev_b32 v64, 16, v132
    v_and_b32 v65, 0xffff0000, v132
    v_fmac_f32 v26, v53, v64
    v_fmac_f32 v27, v53, v65
    v_lshlrev_b32 v64, 16, v133
    v_and_b32 v65, 0xffff0000, v133
    v_fmac_f32 v28, v53, v64
    v_fmac_f32 v29, v53, v65
    v_lshlrev_b32 v64, 16, v134
    v_and_b32 v65, 0xffff0000, v134
    v_fmac_f32 v30, v53, v64
    v_fmac_f32 v31, v53, v65
    v_lshlrev_b32 v64, 16, v135
    v_and_b32 v65, 0xffff0000, v135
    v_fmac_f32 v32, v53, v64
    v_fmac_f32 v33, v53, v65
    ds_write_b128 v66, v[10:13] offset:0
    ds_write_b128 v66, v[14:17] offset:16
    ds_write_b128 v66, v[18:21] offset:256
    ds_write_b128 v66, v[22:25] offset:272
    ds_write_b128 v66, v[26:29] offset:512
    ds_write_b128 v66, v[30:33] offset:528
    v_lshlrev_b32 v64, 3, v7
    ds_write_b64 v64, v[68:69] offset:49536
    s_waitcnt lgkmcnt(0)
    s_barrier
    s_cmp_ge_u32 s3, 3
    s_cbranch_scc1 K1_PUB
    v_lshlrev_b32 v64, 3, v1
    ds_read_b64 v[68:69], v64 offset:49536
    ds_read_b32 v10, v9 offset:0
    ds_read_b32 v11, v9 offset:768
    ds_read_b32 v12, v9 offset:1536
    ds_read_b32 v13, v9 offset:2304
    ds_read_b32 v14, v9 offset:3072
    ds_read_b32 v15, v9 offset:3840
    ds_read_b32 v16, v9 offset:4608
    ds_read_b32 v17, v9 offset:5376
    ds_read_b32 v18, v9 offset:6144
    ds_read_b32 v19, v9 offset:6912
    ds_read_b32 v20, v9 offset:7680
    ds_read_b32 v21, v9 offset:8448
    ds_read_b32 v22, v9 offset:9216
    ds_read_b32 v23, v9 offset:9984
    ds_read_b32 v24, v9 offset:10752
    ds_read_b32 v25, v9 offset:11520
    ds_read_b32 v26, v9 offset:12288
    ds_read_b32 v27, v9 offset:13056
    ds_read_b32 v28, v9 offset:13824
    ds_read_b32 v29, v9 offset:14592
    ds_read_b32 v30, v9 offset:15360
    ds_read_b32 v31, v9 offset:16128
    ds_read_b32 v32, v9 offset:16896
    ds_read_b32 v33, v9 offset:17664
    ds_read_b32 v34, v9 offset:18432
    ds_read_b32 v35, v9 offset:19200
    ds_read_b32 v36, v9 offset:19968
    ds_read_b32 v37, v9 offset:20736
    ds_read_b32 v38, v9 offset:21504
    ds_read_b32 v39, v9 offset:22272
    ds_read_b32 v40, v9 offset:23040
    ds_read_b32 v41, v9 offset:23808
    s_waitcnt lgkmcnt(15)
    s_nop 1
    v_max_f32_dpp v70, v68, v68 quad_perm:[1,0,3,2] row_mask:0xf bank_mask:0xf
    s_nop 1
    v_max_f32_dpp v70, v70, v70 quad_perm:[2,3,0,1] row_mask:0xf bank_mask:0xf
    s_nop 1
    v_max_f32_dpp v70, v70, v70 row_half_mirror row_mask:0xf bank_mask:0xf
    s_nop 1
    v_max_f32_dpp v70, v70, v70 row_mirror row_mask:0xf bank_mask:0xf
    s_nop 1
    v_readlane_b32 s80, v70, 0
    v_readlane_b32 s81, v70, 16
    v_readlane_b32 s82, v70, 32
    v_readlane_b32 s83, v70, 48
    s_nop 1
    v_mov_b32 v70, s80
    v_max_f32 v70, s81, v70
    v_max_f32 v70, s82, v70
    v_max_f32 v70, s83, v70
    v_sub_f32 v68, v68, v70
    v_mul_f32 v68, 0x3fb8aa3b, v68
    v_exp_f32 v68, v68
    s_nop 0
    v_mul_f32 v69, v68, v69
    s_nop 1
    v_add_f32_dpp v71, v69, v69 quad_perm:[1,0,3,2] row_mask:0xf bank_mask:0xf
    s_nop 1
    v_add_f32_dpp v71, v71, v71 quad_perm:[2,3,0,1] row_mask:0xf bank_mask:0xf
    s_nop 1
    v_add_f32_dpp v71, v71, v71 row_half_mirror row_mask:0xf bank_mask:0xf
    s_nop 1
    v_add_f32_dpp v71, v71, v71 row_mirror row_mask:0xf bank_mask:0xf
    s_nop 1
    v_readlane_b32 s80, v71, 0
    v_readlane_b32 s81, v71, 16
    v_readlane_b32 s82, v71, 32
    v_readlane_b32 s83, v71, 48
    s_nop 1
    v_mov_b32 v71, s80
    v_add_f32 v71, s81, v71
    v_add_f32 v71, s82, v71
    v_add_f32 v71, s83, v71
    v_mov_b32 v65, 0
    s_waitcnt lgkmcnt(0)
    v_readlane_b32 s80, v68, 0
    v_readlane_b32 s81, v68, 1
    v_readlane_b32 s82, v68, 2
    v_readlane_b32 s83, v68, 3
    s_nop 0
    v_fmac_f32 v65, s80, v10
    v_fmac_f32 v65, s81, v11
    v_fmac_f32 v65, s82, v12
    v_fmac_f32 v65, s83, v13
    v_readlane_b32 s80, v68, 4
    v_readlane_b32 s81, v68, 5
    v_readlane_b32 s82, v68, 6
    v_readlane_b32 s83, v68, 7
    s_nop 0
    v_fmac_f32 v65, s80, v14
    v_fmac_f32 v65, s81, v15
    v_fmac_f32 v65, s82, v16
    v_fmac_f32 v65, s83, v17
    v_readlane_b32 s80, v68, 8
    v_readlane_b32 s81, v68, 9
    v_readlane_b32 s82, v68, 10
    v_readlane_b32 s83, v68, 11
    s_nop 0
    v_fmac_f32 v65, s80, v18
    v_fmac_f32 v65, s81, v19
    v_fmac_f32 v65, s82, v20
    v_fmac_f32 v65, s83, v21
    v_readlane_b32 s80, v68, 12
    v_readlane_b32 s81, v68, 13
    v_readlane_b32 s82, v68, 14
    v_readlane_b32 s83, v68, 15
    s_nop 0
    v_fmac_f32 v65, s80, v22
    v_fmac_f32 v65, s81, v23
    v_fmac_f32 v65, s82, v24
    v_fmac_f32 v65, s83, v25
    v_readlane_b32 s80, v68, 16
    v_readlane_b32 s81, v68, 17
    v_readlane_b32 s82, v68, 18
    v_readlane_b32 s83, v68, 19
    s_nop 0
    v_fmac_f32 v65, s80, v26
    v_fmac_f32 v65, s81, v27
    v_fmac_f32 v65, s82, v28
    v_fmac_f32 v65, s83, v29
    v_readlane_b32 s80, v68, 20
    v_readlane_b32 s81, v68, 21
    v_readlane_b32 s82, v68, 22
    v_readlane_b32 s83, v68, 23
    s_nop 0
    v_fmac_f32 v65, s80, v30
    v_fmac_f32 v65, s81, v31
    v_fmac_f32 v65, s82, v32
    v_fmac_f32 v65, s83, v33
    v_readlane_b32 s80, v68, 24
    v_readlane_b32 s81, v68, 25
    v_readlane_b32 s82, v68, 26
    v_readlane_b32 s83, v68, 27
    s_nop 0
    v_fmac_f32 v65, s80, v34
    v_fmac_f32 v65, s81, v35
    v_fmac_f32 v65, s82, v36
    v_fmac_f32 v65, s83, v37
    v_readlane_b32 s80, v68, 28
    v_readlane_b32 s81, v68, 29
    v_readlane_b32 s82, v68, 30
    v_readlane_b32 s83, v68, 31
    s_nop 0
    v_fmac_f32 v65, s80, v38
    v_fmac_f32 v65, s81, v39
    v_fmac_f32 v65, s82, v40
    v_fmac_f32 v65, s83, v41
    ds_read_b32 v10, v9 offset:24576
    ds_read_b32 v11, v9 offset:25344
    ds_read_b32 v12, v9 offset:26112
    ds_read_b32 v13, v9 offset:26880
    ds_read_b32 v14, v9 offset:27648
    ds_read_b32 v15, v9 offset:28416
    ds_read_b32 v16, v9 offset:29184
    ds_read_b32 v17, v9 offset:29952
    ds_read_b32 v18, v9 offset:30720
    ds_read_b32 v19, v9 offset:31488
    ds_read_b32 v20, v9 offset:32256
    ds_read_b32 v21, v9 offset:33024
    ds_read_b32 v22, v9 offset:33792
    ds_read_b32 v23, v9 offset:34560
    ds_read_b32 v24, v9 offset:35328
    ds_read_b32 v25, v9 offset:36096
    ds_read_b32 v26, v9 offset:36864
    ds_read_b32 v27, v9 offset:37632
    ds_read_b32 v28, v9 offset:38400
    ds_read_b32 v29, v9 offset:39168
    ds_read_b32 v30, v9 offset:39936
    ds_read_b32 v31, v9 offset:40704
    ds_read_b32 v32, v9 offset:41472
    ds_read_b32 v33, v9 offset:42240
    ds_read_b32 v34, v9 offset:43008
    ds_read_b32 v35, v9 offset:43776
    ds_read_b32 v36, v9 offset:44544
    ds_read_b32 v37, v9 offset:45312
    ds_read_b32 v38, v9 offset:46080
    ds_read_b32 v39, v9 offset:46848
    ds_read_b32 v40, v9 offset:47616
    ds_read_b32 v41, v9 offset:48384
    s_waitcnt lgkmcnt(0)
    v_readlane_b32 s80, v68, 32
    v_readlane_b32 s81, v68, 33
    v_readlane_b32 s82, v68, 34
    v_readlane_b32 s83, v68, 35
    s_nop 0
    v_fmac_f32 v65, s80, v10
    v_fmac_f32 v65, s81, v11
    v_fmac_f32 v65, s82, v12
    v_fmac_f32 v65, s83, v13
    v_readlane_b32 s80, v68, 36
    v_readlane_b32 s81, v68, 37
    v_readlane_b32 s82, v68, 38
    v_readlane_b32 s83, v68, 39
    s_nop 0
    v_fmac_f32 v65, s80, v14
    v_fmac_f32 v65, s81, v15
    v_fmac_f32 v65, s82, v16
    v_fmac_f32 v65, s83, v17
    v_readlane_b32 s80, v68, 40
    v_readlane_b32 s81, v68, 41
    v_readlane_b32 s82, v68, 42
    v_readlane_b32 s83, v68, 43
    s_nop 0
    v_fmac_f32 v65, s80, v18
    v_fmac_f32 v65, s81, v19
    v_fmac_f32 v65, s82, v20
    v_fmac_f32 v65, s83, v21
    v_readlane_b32 s80, v68, 44
    v_readlane_b32 s81, v68, 45
    v_readlane_b32 s82, v68, 46
    v_readlane_b32 s83, v68, 47
    s_nop 0
    v_fmac_f32 v65, s80, v22
    v_fmac_f32 v65, s81, v23
    v_fmac_f32 v65, s82, v24
    v_fmac_f32 v65, s83, v25
    v_readlane_b32 s80, v68, 48
    v_readlane_b32 s81, v68, 49
    v_readlane_b32 s82, v68, 50
    v_readlane_b32 s83, v68, 51
    s_nop 0
    v_fmac_f32 v65, s80, v26
    v_fmac_f32 v65, s81, v27
    v_fmac_f32 v65, s82, v28
    v_fmac_f32 v65, s83, v29
    v_readlane_b32 s80, v68, 52
    v_readlane_b32 s81, v68, 53
    v_readlane_b32 s82, v68, 54
    v_readlane_b32 s83, v68, 55
    s_nop 0
    v_fmac_f32 v65, s80, v30
    v_fmac_f32 v65, s81, v31
    v_fmac_f32 v65, s82, v32
    v_fmac_f32 v65, s83, v33
    v_readlane_b32 s80, v68, 56
    v_readlane_b32 s81, v68, 57
    v_readlane_b32 s82, v68, 58
    v_readlane_b32 s83, v68, 59
    s_nop 0
    v_fmac_f32 v65, s80, v34
    v_fmac_f32 v65, s81, v35
    v_fmac_f32 v65, s82, v36
    v_fmac_f32 v65, s83, v37
    v_readlane_b32 s80, v68, 60
    v_readlane_b32 s81, v68, 61
    v_readlane_b32 s82, v68, 62
    v_readlane_b32 s83, v68, 63
    s_nop 0
    v_fmac_f32 v65, s80, v38
    v_fmac_f32 v65, s81, v39
    v_fmac_f32 v65, s82, v40
    v_fmac_f32 v65, s83, v41
    v_mov_b32 v64, v65
    v_mov_b32 v65, s99
    s_lshl_b32 s8, s4, 3
    s_add_u32 s8, s8, s13
    s_lshl_b32 s8, s8, 11
    v_lshl_add_u32 v66, v0, 3, s8
    buffer_store_dwordx2 v[64:65], v66, s[76:79], 0 offen sc1
    v_mov_b32 v68, v70
    v_mov_b32 v69, s99
    v_mov_b32 v70, v71
    v_mov_b32 v71, s99
    v_mov_b32 v67, s8
    s_cmp_lg_u32 s3, 0
    s_cbranch_scc1 K1_NOML
    s_mov_b64 exec, 1
    buffer_store_dwordx4 v[68:71], v67, s[76:79], 0 offen offset:1536 sc1
    s_mov_b64 exec, -1
K1_NOML:
    s_lshl_b32 s8, s4, 14
    v_lshl_add_u32 v64, v0, 3, s8
    v_mov_b32 v65, s8
    s_mov_b32 s9, 0
K1_POLL:
    s_mov_b32 s10, 0
    buffer_load_dwordx4 v[26:29], v65, s[76:79], s10 offen offset:1536 sc1
    buffer_load_dwordx2 v[10:11], v64, s[76:79], s10 offen sc1
    s_mov_b32 s10, 2048
    buffer_load_dwordx4 v[30:33], v65, s[76:79], s10 offen offset:1536 sc1
    buffer_load_dwordx2 v[12:13], v64, s[76:79], s10 offen sc1
    s_mov_b32 s10, 4096
    buffer_load_dwordx4 v[34:37], v65, s[76:79], s10 offen offset:1536 sc1
    buffer_load_dwordx2 v[14:15], v64, s[76:79], s10 offen sc1
    s_mov_b32 s10, 6144
    buffer_load_dwordx4 v[38:41], v65, s[76:79], s10 offen offset:1536 sc1
    buffer_load_dwordx2 v[16:17], v64, s[76:79], s10 offen sc1
    s_mov_b32 s10, 8192
    buffer_load_dwordx4 v[42:45], v65, s[76:79], s10 offen offset:1536 sc1
    buffer_load_dwordx2 v[18:19], v64, s[76:79], s10 offen sc1
    s_mov_b32 s10, 10240
    buffer_load_dwordx4 v[46:49], v65, s[76:79], s10 offen offset:1536 sc1
    buffer_load_dwordx2 v[20:21], v64, s[76:79], s10 offen sc1
    s_mov_b32 s10, 12288
    buffer_load_dwordx4 v[50:53], v65, s[76:79], s10 offen offset:1536 sc1
    buffer_load_dwordx2 v[22:23], v64, s[76:79], s10 offen sc1
    s_mov_b32 s10, 14336
    buffer_load_dwordx4 v[54:57], v65, s[76:79], s10 offen offset:1536 sc1
    buffer_load_dwordx2 v[24:25], v64, s[76:79], s10 offen sc1
    s_waitcnt vmcnt(0)
    v_xor_b32 v66, s99, v11
    v_xor_b32 v67, s99, v27
    v_or_b32 v66, v66, v67
    v_xor_b32 v67, s99, v29
    v_or_b32 v66, v66, v67
    v_xor_b32 v67, s99, v13
    v_or_b32 v66, v66, v67
    v_xor_b32 v67, s99, v31
    v_or_b32 v66, v66, v67
    v_xor_b32 v67, s99, v33
    v_or_b32 v66, v66, v67
    v_xor_b32 v67, s99, v15
    v_or_b32 v66, v66, v67
    v_xor_b32 v67, s99, v35
    v_or_b32 v66, v66, v67
    v_xor_b32 v67, s99, v37
    v_or_b32 v66, v66, v67
    v_xor_b32 v67, s99, v17
    v_or_b32 v66, v66, v67
    v_xor_b32 v67, s99, v39
    v_or_b32 v66, v66, v67
    v_xor_b32 v67, s99, v41
    v_or_b32 v66, v66, v67
    v_xor_b32 v67, s99, v19
    v_or_b32 v66, v66, v67
    v_xor_b32 v67, s99, v43
    v_or_b32 v66, v66, v67
    v_xor_b32 v67, s99, v45
    v_or_b32 v66, v66, v67
    v_xor_b32 v67, s99, v21
    v_or_b32 v66, v66, v67
    v_xor_b32 v67, s99, v47
    v_or_b32 v66, v66, v67
    v_xor_b32 v67, s99, v49
    v_or_b32 v66, v66, v67
    v_xor_b32 v67, s99, v23
    v_or_b32 v66, v66, v67
    v_xor_b32 v67, s99, v51
    v_or_b32 v66, v66, v67
    v_xor_b32 v67, s99, v53
    v_or_b32 v66, v66, v67
    v_xor_b32 v67, s99, v25
    v_or_b32 v66, v66, v67
    v_xor_b32 v67, s99, v55
    v_or_b32 v66, v66, v67
    v_xor_b32 v67, s99, v57
    v_or_b32 v66, v66, v67
    v_cmp_ne_u32 vcc, 0, v66
    s_add_u32 s9, s9, 1
    s_cmp_ge_u32 s9, 0x40000
    s_cbranch_scc1 K1_POLLED
    s_cbranch_vccz K1_POLLED
    s_sleep 1
    s_branch K1_POLL
K1_POLLED:
    v_max_f32 v66, v26, v30
    v_max_f32 v66, v66, v34
    v_max_f32 v66, v66, v38
    v_max_f32 v66, v66, v42
    v_max_f32 v66, v66, v46
    v_max_f32 v66, v66, v50
    v_max_f32 v66, v66, v54
    v_mov_b32 v67, 0
    v_mov_b32 v68, 0
    v_sub_f32 v26, v26, v66
    v_mul_f32 v26, 0x3fb8aa3b, v26
    v_exp_f32 v26, v26
    v_sub_f32 v30, v30, v66
    v_mul_f32 v30, 0x3fb8aa3b, v30
    v_exp_f32 v30, v30
    v_sub_f32 v34, v34, v66
    v_mul_f32 v34, 0x3fb8aa3b, v34
    v_exp_f32 v34, v34
    v_sub_f32 v38, v38, v66
    v_mul_f32 v38, 0x3fb8aa3b, v38
    v_exp_f32 v38, v38
    v_sub_f32 v42, v42, v66
    v_mul_f32 v42, 0x3fb8aa3b, v42
    v_exp_f32 v42, v42
    v_sub_f32 v46, v46, v66
    v_mul_f32 v46, 0x3fb8aa3b, v46
    v_exp_f32 v46, v46
    v_sub_f32 v50, v50, v66
    v_mul_f32 v50, 0x3fb8aa3b, v50
    v_exp_f32 v50, v50
    v_sub_f32 v54, v54, v66
    v_mul_f32 v54, 0x3fb8aa3b, v54
    v_exp_f32 v54, v54
    s_nop 0
    v_fmac_f32 v67, v26, v10
    v_fmac_f32 v68, v26, v28
    v_fmac_f32 v67, v30, v12
    v_fmac_f32 v68, v30, v32
    v_fmac_f32 v67, v34, v14
    v_fmac_f32 v68, v34, v36
    v_fmac_f32 v67, v38, v16
    v_fmac_f32 v68, v38, v40
    v_fmac_f32 v67, v42, v18
    v_fmac_f32 v68, v42, v44
    v_fmac_f32 v67, v46, v20
    v_fmac_f32 v68, v46, v48
    v_fmac_f32 v67, v50, v22
    v_fmac_f32 v68, v50, v52
    v_fmac_f32 v67, v54, v24
    v_fmac_f32 v68, v54, v56
    v_rcp_f32 v69, v68
    s_nop 0
    v_mul_f32 v66, v67, v69
    v_fma_f32 v67, -v66, v68, v67
    v_fma_f32 v66, v67, v69, v66
    v_cvt_pk_bf16_f32 v66, v66, v66
    v_lshlrev_b32 v66, 16, v66
    ds_write_b32 v9, v66 offset:50560
K1_PUB:
    s_waitcnt vmcnt(0)
    s_waitcnt lgkmcnt(0)
    s_barrier
    v_mul_u32_u24 v64, 205, v0
    v_lshrrev_b32 v64, 11, v64
    v_mul_u32_u24 v65, 10, v64
    v_sub_u32 v65, v0, v65
    v_lshlrev_b32 v66, 2, v64
    ds_read_b32 v10, v66 offset:50560
    ds_read_b32 v11, v66 offset:50752
    ds_read_b32 v12, v66 offset:50944
    ds_read_b32 v13, v66 offset:51136
    v_mov_b32 v18, 0
    v_mov_b32 v19, 0
    v_mov_b32 v20, 0
    v_mov_b32 v21, 0
    v_mov_b32 v22, 0
    v_mov_b32 v23, 0
    v_mov_b32 v24, 0
    v_mov_b32 v25, 0
    s_waitcnt lgkmcnt(0)
    v_lshlrev_b32 v67, 16, v148
    v_and_b32 v68, 0xffff0000, v148
    v_fmac_f32 v18, v10, v67
    v_fmac_f32 v19, v10, v68
    v_lshlrev_b32 v67, 16, v149
    v_and_b32 v68, 0xffff0000, v149
    v_fmac_f32 v20, v10, v67
    v_fmac_f32 v21, v10, v68
    v_lshlrev_b32 v67, 16, v150
    v_and_b32 v68, 0xffff0000, v150
    v_fmac_f32 v22, v10, v67
    v_fmac_f32 v23, v10, v68
    v_lshlrev_b32 v67, 16, v151
    v_and_b32 v68, 0xffff0000, v151
    v_fmac_f32 v24, v10, v67
    v_fmac_f32 v25, v10, v68
    v_lshlrev_b32 v67, 16, v152
    v_and_b32 v68, 0xffff0000, v152
    v_fmac_f32 v18, v11, v67
    v_fmac_f32 v19, v11, v68
    v_lshlrev_b32 v67, 16, v153
    v_and_b32 v68, 0xffff0000, v153
    v_fmac_f32 v20, v11, v67
    v_fmac_f32 v21, v11, v68
    v_lshlrev_b32 v67, 16, v154
    v_and_b32 v68, 0xffff0000, v154
    v_fmac_f32 v22, v11, v67
    v_fmac_f32 v23, v11, v68
    v_lshlrev_b32 v67, 16, v155
    v_and_b32 v68, 0xffff0000, v155
    v_fmac_f32 v24, v11, v67
    v_fmac_f32 v25, v11, v68
    v_lshlrev_b32 v67, 16, v156
    v_and_b32 v68, 0xffff0000, v156
    v_fmac_f32 v18, v12, v67
    v_fmac_f32 v19, v12, v68
    v_lshlrev_b32 v67, 16, v157
    v_and_b32 v68, 0xffff0000, v157
    v_fmac_f32 v20, v12, v67
    v_fmac_f32 v21, v12, v68
    v_lshlrev_b32 v67, 16, v158
    v_and_b32 v68, 0xffff0000, v158
    v_fmac_f32 v22, v12, v67
    v_fmac_f32 v23, v12, v68
    v_lshlrev_b32 v67, 16, v159
    v_and_b32 v68, 0xffff0000, v159
    v_fmac_f32 v24, v12, v67
    v_fmac_f32 v25, v12, v68
    v_lshlrev_b32 v67, 16, v172
    v_and_b32 v68, 0xffff0000, v172
    v_fmac_f32 v18, v13, v67
    v_fmac_f32 v19, v13, v68
    v_lshlrev_b32 v67, 16, v173
    v_and_b32 v68, 0xffff0000, v173
    v_fmac_f32 v20, v13, v67
    v_fmac_f32 v21, v13, v68
    v_lshlrev_b32 v67, 16, v174
    v_and_b32 v68, 0xffff0000, v174
    v_fmac_f32 v22, v13, v67
    v_fmac_f32 v23, v13, v68
    v_lshlrev_b32 v67, 16, v175
    v_and_b32 v68, 0xffff0000, v175
    v_fmac_f32 v24, v13, v67
    v_fmac_f32 v25, v13, v68
    v_mul_u32_u24 v66, 320, v64
    v_lshl_add_u32 v66, v65, 5, v66
    ds_write_b128 v66, v[18:21] offset:0
    ds_write_b128 v66, v[22:25] offset:16
    s_waitcnt lgkmcnt(0)
    s_barrier
    s_cmp_lg_u32 s3, 0
    s_cbranch_scc1 K1_END
    s_mov_b32 s8, -1
    s_mov_b32 s9, 0xff
    s_mov_b64 exec, s[8:9]
    v_lshlrev_b32 v64, 3, v1
    ds_read_b64 v[88:89], v64 offset:0
    ds_read_b64 v[90:91], v64 offset:320
    ds_read_b64 v[92:93], v64 offset:640
    ds_read_b64 v[94:95], v64 offset:960
    ds_read_b64 v[96:97], v64 offset:1280
    ds_read_b64 v[98:99], v64 offset:1600
    ds_read_b64 v[100:101], v64 offset:1920
    ds_read_b64 v[102:103], v64 offset:2240
    ds_read_b64 v[104:105], v64 offset:2560
    ds_read_b64 v[106:107], v64 offset:2880
    ds_read_b64 v[108:109], v64 offset:3200
    ds_read_b64 v[110:111], v64 offset:3520
    ds_read_b64 v[112:113], v64 offset:3840
    ds_read_b64 v[114:115], v64 offset:4160
    ds_read_b64 v[116:117], v64 offset:4480
    ds_read_b64 v[118:119], v64 offset:4800
    ds_read_b64 v[120:121], v64 offset:5120
    ds_read_b64 v[122:123], v64 offset:5440
    ds_read_b64 v[124:125], v64 offset:5760
    ds_read_b64 v[126:127], v64 offset:6080
    ds_read_b64 v[128:129], v64 offset:6400
    ds_read_b64 v[130:131], v64 offset:6720
    ds_read_b64 v[132:133], v64 offset:7040
    ds_read_b64 v[134:135], v64 offset:7360
    ds_read_b64 v[136:137], v64 offset:7680
    ds_read_b64 v[138:139], v64 offset:8000
    ds_read_b64 v[140:141], v64 offset:8320
    ds_read_b64 v[142:143], v64 offset:8640
    ds_read_b64 v[144:145], v64 offset:8960
    ds_read_b64 v[146:147], v64 offset:9280
    ds_read_b64 v[148:149], v64 offset:9600
    ds_read_b64 v[150:151], v64 offset:9920
    ds_read_b64 v[152:153], v64 offset:10240
    ds_read_b64 v[154:155], v64 offset:10560
    ds_read_b64 v[156:157], v64 offset:10880
    ds_read_b64 v[158:159], v64 offset:11200
    ds_read_b64 v[160:161], v64 offset:11520
    ds_read_b64 v[162:163], v64 offset:11840
    ds_read_b64 v[164:165], v64 offset:12160
    ds_read_b64 v[166:167], v64 offset:12480
    ds_read_b64 v[168:169], v64 offset:12800
    ds_read_b64 v[170:171], v64 offset:13120
    ds_read_b64 v[172:173], v64 offset:13440
    ds_read_b64 v[174:175], v64 offset:13760
    ds_read_b64 v[176:177], v64 offset:14080
    ds_read_b64 v[178:179], v64 offset:14400
    ds_read_b64 v[180:181], v64 offset:14720
    ds_read_b64 v[182:183], v64 offset:15040
    s_waitcnt lgkmcnt(0)
    v_add_f32 v88, v88, v90
    v_add_f32 v89, v89, v91
    v_add_f32 v88, v88, v92
    v_add_f32 v89, v89, v93
    v_add_f32 v88, v88, v94
    v_add_f32 v89, v89, v95
    v_add_f32 v88, v88, v96
    v_add_f32 v89, v89, v97
    v_add_f32 v88, v88, v98
    v_add_f32 v89, v89, v99
    v_add_f32 v88, v88, v100
    v_add_f32 v89, v89, v101
    v_add_f32 v88, v88, v102
    v_add_f32 v89, v89, v103
    v_add_f32 v88, v88, v104
    v_add_f32 v89, v89, v105
    v_add_f32 v88, v88, v106
    v_add_f32 v89, v89, v107
    v_add_f32 v88, v88, v108
    v_add_f32 v89, v89, v109
    v_add_f32 v88, v88, v110
    v_add_f32 v89, v89, v111
    v_add_f32 v88, v88, v112
    v_add_f32 v89, v89, v113
    v_add_f32 v88, v88, v114
    v_add_f32 v89, v89, v115
    v_add_f32 v88, v88, v116
    v_add_f32 v89, v89, v117
    v_add_f32 v88, v88, v118
    v_add_f32 v89, v89, v119
    v_add_f32 v88, v88, v120
    v_add_f32 v89, v89, v121
    v_add_f32 v88, v88, v122
    v_add_f32 v89, v89, v123
    v_add_f32 v88, v88, v124
    v_add_f32 v89, v89, v125
    v_add_f32 v88, v88, v126
    v_add_f32 v89, v89, v127
    v_add_f32 v88, v88, v128
    v_add_f32 v89, v89, v129
    v_add_f32 v88, v88, v130
    v_add_f32 v89, v89, v131
    v_add_f32 v88, v88, v132
    v_add_f32 v89, v89, v133
    v_add_f32 v88, v88, v134
    v_add_f32 v89, v89, v135
    v_add_f32 v88, v88, v136
    v_add_f32 v89, v89, v137
    v_add_f32 v88, v88, v138
    v_add_f32 v89, v89, v139
    v_add_f32 v88, v88, v140
    v_add_f32 v89, v89, v141
    v_add_f32 v88, v88, v142
    v_add_f32 v89, v89, v143
    v_add_f32 v88, v88, v144
    v_add_f32 v89, v89, v145
    v_add_f32 v88, v88, v146
    v_add_f32 v89, v89, v147
    v_add_f32 v88, v88, v148
    v_add_f32 v89, v89, v149
    v_add_f32 v88, v88, v150
    v_add_f32 v89, v89, v151
    v_add_f32 v88, v88, v152
    v_add_f32 v89, v89, v153
    v_add_f32 v88, v88, v154
    v_add_f32 v89, v89, v155
    v_add_f32 v88, v88, v156
    v_add_f32 v89, v89, v157
    v_add_f32 v88, v88, v158
    v_add_f32 v89, v89, v159
    v_add_f32 v88, v88, v160
    v_add_f32 v89, v89, v161
    v_add_f32 v88, v88, v162
    v_add_f32 v89, v89, v163
    v_add_f32 v88, v88, v164
    v_add_f32 v89, v89, v165
    v_add_f32 v88, v88, v166
    v_add_f32 v89, v89, v167
    v_add_f32 v88, v88, v168
    v_add_f32 v89, v89, v169
    v_add_f32 v88, v88, v170
    v_add_f32 v89, v89, v171
    v_add_f32 v88, v88, v172
    v_add_f32 v89, v89, v173
    v_add_f32 v88, v88, v174
    v_add_f32 v89, v89, v175
    v_add_f32 v88, v88, v176
    v_add_f32 v89, v89, v177
    v_add_f32 v88, v88, v178
    v_add_f32 v89, v89, v179
    v_add_f32 v88, v88, v180
    v_add_f32 v89, v89, v181
    v_add_f32 v88, v88, v182
    v_add_f32 v89, v89, v183
    v_mov_b32 v90, v89
    v_mov_b32 v89, s99
    v_mov_b32 v91, s99
    s_lshl_b32 s8, s13, 5
    s_add_u32 s8, s8, s4
    s_lshl_b32 s8, s8, 10
    s_add_u32 s8, s8, 532480
    v_lshl_add_u32 v65, v1, 4, s8
    buffer_store_dwordx4 v[88:91], v65, s[76:79], 0 offen sc1
    s_cmp_lg_u32 s4, 0
    s_cbranch_scc1 K1_FIN
    s_lshl_b32 s8, s13, 15
    s_add_u32 s8, s8, 532480
    v_lshl_add_u32 v65, v1, 4, s8
    s_mul_i32 s8, s13, 640
    s_add_u32 s8, s8, 524288
    v_lshl_add_u32 v67, v1, 4, s8
    s_mul_i32 s8, s13, 160
    v_lshlrev_b32 v66, 2, v1
    v_add_u32 v66, s8, v66
    buffer_load_dword v72, v66, s[44:47], 0 offen
    s_mov_b32 s9, 0
K1_POLL2:
    s_mov_b32 s10, 0
    buffer_load_dwordx4 v[88:91], v65, s[76:79], s10 offen sc1
    s_mov_b32 s10, 1024
    buffer_load_dwordx4 v[92:95], v65, s[76:79], s10 offen sc1
    s_mov_b32 s10, 2048
    buffer_load_dwordx4 v[96:99], v65, s[76:79], s10 offen sc1
    s_mov_b32 s10, 3072
    buffer_load_dwordx4 v[100:103], v65, s[76:79], s10 offen sc1
    s_mov_b32 s10, 4096
    buffer_load_dwordx4 v[104:107], v65, s[76:79], s10 offen sc1
    s_mov_b32 s10, 5120
    buffer_load_dwordx4 v[108:111], v65, s[76:79], s10 offen sc1
    s_mov_b32 s10, 6144
    buffer_load_dwordx4 v[112:115], v65, s[76:79], s10 offen sc1
    s_mov_b32 s10, 7168
    buffer_load_dwordx4 v[116:119], v65, s[76:79], s10 offen sc1
    s_mov_b32 s10, 8192
    buffer_load_dwordx4 v[120:123], v65, s[76:79], s10 offen sc1
    s_mov_b32 s10, 9216
    buffer_load_dwordx4 v[124:127], v65, s[76:79], s10 offen sc1
    s_mov_b32 s10, 10240
    buffer_load_dwordx4 v[128:131], v65, s[76:79], s10 offen sc1
    s_mov_b32 s10, 11264
    buffer_load_dwordx4 v[132:135], v65, s[76:79], s10 offen sc1
    s_mov_b32 s10, 12288
    buffer_load_dwordx4 v[136:139], v65, s[76:79], s10 offen sc1
    s_mov_b32 s10, 13312
    buffer_load_dwordx4 v[140:143], v65, s[76:79], s10 offen sc1
    s_mov_b32 s10, 14336
    buffer_load_dwordx4 v[144:147], v65, s[76:79], s10 offen sc1
    s_mov_b32 s10, 15360
    buffer_load_dwordx4 v[148:151], v65, s[76:79], s10 offen sc1
    s_mov_b32 s10, 16384
    buffer_load_dwordx4 v[152:155], v65, s[76:79], s10 offen sc1
    s_mov_b32 s10, 17408
    buffer_load_dwordx4 v[156:159], v65, s[76:79], s10 offen sc1
    s_mov_b32 s10, 18432
    buffer_load_dwordx4 v[160:163], v65, s[76:79], s10 offen sc1
    s_mov_b32 s10, 19456
    buffer_load_dwordx4 v[164:167], v65, s[76:79], s10 offen sc1
    s_mov_b32 s10, 20480
    buffer_load_dwordx4 v[168:171], v65, s[76:79], s10 offen sc1
    s_mov_b32 s10, 21504
    buffer_load_dwordx4 v[172:175], v65, s[76:79], s10 offen sc1
    s_mov_b32 s10, 22528
    buffer_load_dwordx4 v[176:179], v65, s[76:79], s10 offen sc1
    s_mov_b32 s10, 23552
    buffer_load_dwordx4 v[180:183], v65, s[76:79], s10 offen sc1
    s_mov_b32 s10, 24576
    buffer_load_dwordx4 v[184:187], v65, s[76:79], s10 offen sc1
    s_mov_b32 s10, 25600
    buffer_load_dwordx4 v[188:191], v65, s[76:79], s10 offen sc1
    s_mov_b32 s10, 26624
    buffer_load_dwordx4 v[192:195], v65, s[76:79], s10 offen sc1
    s_mov_b32 s10, 27648
    buffer_load_dwordx4 v[196:199], v65, s[76:79], s10 offen sc1
    s_mov_b32 s10, 28672
    buffer_load_dwordx4 v[200:203], v65, s[76:79], s10 offen sc1
    s_mov_b32 s10, 29696
    buffer_load_dwordx4 v[204:207], v65, s[76:79], s10 offen sc1
    s_mov_b32 s10, 30720
    buffer_load_dwordx4 v[208:211], v65, s[76:79], s10 offen sc1
    s_mov_b32 s10, 31744
    buffer_load_dwordx4 v[212:215], v65, s[76:79], s10 offen sc1
    buffer_load_dwordx4 v[68:71], v67, s[76:79], 0 offen sc1
    s_waitcnt vmcnt(0)
    v_xor_b32 v10, s99, v69
    v_xor_b32 v11, s99, v71
    v_or_b32 v10, v10, v11
    v_xor_b32 v11, s99, v89
    v_or_b32 v10, v10, v11
    v_xor_b32 v11, s99, v91
    v_or_b32 v10, v10, v11
    v_xor_b32 v11, s99, v93
    v_or_b32 v10, v10, v11
    v_xor_b32 v11, s99, v95
    v_or_b32 v10, v10, v11
    v_xor_b32 v11, s99, v97
    v_or_b32 v10, v10, v11
    v_xor_b32 v11, s99, v99
    v_or_b32 v10, v10, v11
    v_xor_b32 v11, s99, v101
    v_or_b32 v10, v10, v11
    v_xor_b32 v11, s99, v103
    v_or_b32 v10, v10, v11
    v_xor_b32 v11, s99, v105
    v_or_b32 v10, v10, v11
    v_xor_b32 v11, s99, v107
    v_or_b32 v10, v10, v11
    v_xor_b32 v11, s99, v109
    v_or_b32 v10, v10, v11
    v_xor_b32 v11, s99, v111
    v_or_b32 v10, v10, v11
    v_xor_b32 v11, s99, v113
    v_or_b32 v10, v10, v11
    v_xor_b32 v11, s99, v115
    v_or_b32 v10, v10, v11
    v_xor_b32 v11, s99, v117
    v_or_b32 v10, v10, v11
    v_xor_b32 v11, s99, v119
    v_or_b32 v10, v10, v11
    v_xor_b32 v11, s99, v121
    v_or_b32 v10, v10, v11
    v_xor_b32 v11, s99, v123
    v_or_b32 v10, v10, v11
    v_xor_b32 v11, s99, v125
    v_or_b32 v10, v10, v11
    v_xor_b32 v11, s99, v127
    v_or_b32 v10, v10, v11
    v_xor_b32 v11, s99, v129
    v_or_b32 v10, v10, v11
    v_xor_b32 v11, s99, v131
    v_or_b32 v10, v10, v11
    v_xor_b32 v11, s99, v133
    v_or_b32 v10, v10, v11
    v_xor_b32 v11, s99, v135
    v_or_b32 v10, v10, v11
    v_xor_b32 v11, s99, v137
    v_or_b32 v10, v10, v11
    v_xor_b32 v11, s99, v139
    v_or_b32 v10, v10, v11
    v_xor_b32 v11, s99, v141
    v_or_b32 v10, v10, v11
    v_xor_b32 v11, s99, v143
    v_or_b32 v10, v10, v11
    v_xor_b32 v11, s99, v145
    v_or_b32 v10, v10, v11
    v_xor_b32 v11, s99, v147
    v_or_b32 v10, v10, v11
    v_xor_b32 v11, s99, v149
    v_or_b32 v10, v10, v11
    v_xor_b32 v11, s99, v151
    v_or_b32 v10, v10, v11
    v_xor_b32 v11, s99, v153
    v_or_b32 v10, v10, v11
    v_xor_b32 v11, s99, v155
    v_or_b32 v10, v10, v11
    v_xor_b32 v11, s99, v157
    v_or_b32 v10, v10, v11
    v_xor_b32 v11, s99, v159
    v_or_b32 v10, v10, v11
    v_xor_b32 v11, s99, v161
    v_or_b32 v10, v10, v11
    v_xor_b32 v11, s99, v163
    v_or_b32 v10, v10, v11
    v_xor_b32 v11, s99, v165
    v_or_b32 v10, v10, v11
    v_xor_b32 v11, s99, v167
    v_or_b32 v10, v10, v11
    v_xor_b32 v11, s99, v169
    v_or_b32 v10, v10, v11
    v_xor_b32 v11, s99, v171
    v_or_b32 v10, v10, v11
    v_xor_b32 v11, s99, v173
    v_or_b32 v10, v10, v11
    v_xor_b32 v11, s99, v175
    v_or_b32 v10, v10, v11
    v_xor_b32 v11, s99, v177
    v_or_b32 v10, v10, v11
    v_xor_b32 v11, s99, v179
    v_or_b32 v10, v10, v11
    v_xor_b32 v11, s99, v181
    v_or_b32 v10, v10, v11
    v_xor_b32 v11, s99, v183
    v_or_b32 v10, v10, v11
    v_xor_b32 v11, s99, v185
    v_or_b32 v10, v10, v11
    v_xor_b32 v11, s99, v187
    v_or_b32 v10, v10, v11
    v_xor_b32 v11, s99, v189
    v_or_b32 v10, v10, v11
    v_xor_b32 v11, s99, v191
    v_or_b32 v10, v10, v11
    v_xor_b32 v11, s99, v193
    v_or_b32 v10, v10, v11
    v_xor_b32 v11, s99, v195
    v_or_b32 v10, v10, v11
    v_xor_b32 v11, s99, v197
    v_or_b32 v10, v10, v11
    v_xor_b32 v11, s99, v199
    v_or_b32 v10, v10, v11
    v_xor_b32 v11, s99, v201
    v_or_b32 v10, v10, v11
    v_xor_b32 v11, s99, v203
    v_or_b32 v10, v10, v11
    v_xor_b32 v11, s99, v205
    v_or_b32 v10, v10, v11
    v_xor_b32 v11, s99, v207
    v_or_b32 v10, v10, v11
    v_xor_b32 v11, s99, v209
    v_or_b32 v10, v10, v11
    v_xor_b32 v11, s99, v211
    v_or_b32 v10, v10, v11
    v_xor_b32 v11, s99, v213
    v_or_b32 v10, v10, v11
    v_xor_b32 v11, s99, v215
    v_or_b32 v10, v10, v11
    v_cmp_ne_u32 vcc, 0, v10
    s_add_u32 s9, s9, 1
    s_cmp_ge_u32 s9, 0x40000
    s_cbranch_scc1 K1_POLLED2
    s_cbranch_vccz K1_POLLED2
    s_sleep 1
    s_branch K1_POLL2
K1_POLLED2:
    v_add_f32 v88, v88, v92
    v_add_f32 v90, v90, v94
    v_add_f32 v88, v88, v96
    v_add_f32 v90, v90, v98
    v_add_f32 v88, v88, v100
    v_add_f32 v90, v90, v102
    v_add_f32 v88, v88, v104
    v_add_f32 v90, v90, v106
    v_add_f32 v88, v88, v108
    v_add_f32 v90, v90, v110
    v_add_f32 v88, v88, v112
    v_add_f32 v90, v90, v114
    v_add_f32 v88, v88, v116
    v_add_f32 v90, v90, v118
    v_add_f32 v88, v88, v120
    v_add_f32 v90, v90, v122
    v_add_f32 v88, v88, v124
    v_add_f32 v90, v90, v126
    v_add_f32 v88, v88, v128
    v_add_f32 v90, v90, v130
    v_add_f32 v88, v88, v132
    v_add_f32 v90, v90, v134
    v_add_f32 v88, v88, v136
    v_add_f32 v90, v90, v138
    v_add_f32 v88, v88, v140
    v_add_f32 v90, v90, v142
    v_add_f32 v88, v88, v144
    v_add_f32 v90, v90, v146
    v_add_f32 v88, v88, v148
    v_add_f32 v90, v90, v150
    v_add_f32 v88, v88, v152
    v_add_f32 v90, v90, v154
    v_add_f32 v88, v88, v156
    v_add_f32 v90, v90, v158
    v_add_f32 v88, v88, v160
    v_add_f32 v90, v90, v162
    v_add_f32 v88, v88, v164
    v_add_f32 v90, v90, v166
    v_add_f32 v88, v88, v168
    v_add_f32 v90, v90, v170
    v_add_f32 v88, v88, v172
    v_add_f32 v90, v90, v174
    v_add_f32 v88, v88, v176
    v_add_f32 v90, v90, v178
    v_add_f32 v88, v88, v180
    v_add_f32 v90, v90, v182
    v_add_f32 v88, v88, v184
    v_add_f32 v90, v90, v186
    v_add_f32 v88, v88, v188
    v_add_f32 v90, v90, v190
    v_add_f32 v88, v88, v192
    v_add_f32 v90, v90, v194
    v_add_f32 v88, v88, v196
    v_add_f32 v90, v90, v198
    v_add_f32 v88, v88, v200
    v_add_f32 v90, v90, v202
    v_add_f32 v88, v88, v204
    v_add_f32 v90, v90, v206
    v_add_f32 v88, v88, v208
    v_add_f32 v90, v90, v210
    v_add_f32 v88, v88, v212
    v_add_f32 v90, v90, v214
    v_and_b32 v73, 0xffff0000, v72
    v_lshlrev_b32 v72, 16, v72
    v_cvt_pk_bf16_f32 v88, v88, v88
    v_lshlrev_b32 v88, 16, v88
    v_mul_f32 v88, v88, v68
    v_cvt_pk_bf16_f32 v88, v88, v88
    v_lshlrev_b32 v88, 16, v88
    v_add_f32 v88, v88, v72
    v_cvt_pk_bf16_f32 v90, v90, v90
    v_lshlrev_b32 v90, 16, v90
    v_mul_f32 v90, v90, v70
    v_cvt_pk_bf16_f32 v90, v90, v90
    v_lshlrev_b32 v90, 16, v90
    v_add_f32 v90, v90, v73
    v_cvt_pk_bf16_f32 v88, v88, v90
    buffer_store_dword v88, v66, s[92:95], 0 offen
K1_FIN:
    s_mov_b64 exec, -1
K1_END:
    s_endpgm
.section .rodata,"a"
.p2align 6
.amdhsa_kernel recurrent_scan__sliding_block_cached__mixer_token_mlp__decode_kernel
  .amdhsa_next_free_vgpr 256
  .amdhsa_next_free_sgpr 102
  .amdhsa_accum_offset 256
  .amdhsa_group_segment_fixed_size 0
  .amdhsa_kernarg_size 104
  .amdhsa_user_sgpr_count 2
  .amdhsa_user_sgpr_kernarg_segment_ptr 1
  .amdhsa_system_sgpr_workgroup_id_x 1
.end_amdhsa_kernel
```
